```python
import torch

def _softmax(x, axis=-1):
    return torch.softmax(x, dim=axis)
def _gelu(x):
    return torch.nn.functional.gelu(x, approximate="tanh")
def _silu(x):
    return torch.nn.functional.silu(x)
def _sigmoid(x):
    return torch.sigmoid(x)
def _layernorm(x, axis=-1, eps=1e-5):
    m = x.mean(dim=axis, keepdim=True)
    v = x.var(dim=axis, keepdim=True, unbiased=False)
    return (x - m) / torch.sqrt(v + eps)
def _scatter_add(tgt, idx, src, axis=0):
    return tgt.clone().index_add_(axis, idx, src)
def _segment_sum(src, seg, n):
    out = torch.zeros((n,) + src.shape[1:], dtype=src.dtype)
    return out.index_add_(0, seg, src)
def _pad(x, pw):
    flat = tuple(v for pair in reversed(pw) for v in pair)
    return torch.nn.functional.pad(x, flat)

kernel_name = 'recurrent_scan__mha_block__swiglu_ffn__prompt'

def setup_inputs():

    _w = (lambda a: (lambda t: t.to(torch.bfloat16) if t.is_floating_point() else t)(torch.as_tensor(a)))
    def _A_setup():
        B, S, D, H = 1, 2048, 448, 16
        return {
            "x": _w((lambda *s: torch.randn(*s, dtype=torch.bfloat16) * 0.05)(B, S, D)),
            "wqkv": _w((lambda *s: torch.randn(*s, dtype=torch.bfloat16) * 0.05)(D, 3 * D)),
            "wo": _w((lambda *s: torch.randn(*s, dtype=torch.bfloat16) * 0.05)(D, D)),
        }
    _A_in = _A_setup()

    def _B_setup():
        B, S, D, F = 1, 2048, 448, 1792
        return {
            "x": _w((lambda *s: torch.randn(*s, dtype=torch.bfloat16) * 0.05)(B, S, D)),
            "w_gate": _w((lambda *s: torch.randn(*s, dtype=torch.bfloat16) * 0.05)(D, F)),
            "w_up": _w((lambda *s: torch.randn(*s, dtype=torch.bfloat16) * 0.05)(D, F)),
            "w_down": _w((lambda *s: torch.randn(*s, dtype=torch.bfloat16) * 0.05)(F, D)),
        }
    _B_in = _B_setup()

    return {
        "A_x": _A_in["x"],
        "A_wqkv": _A_in["wqkv"],
        "A_wo": _A_in["wo"],
        "B_x": _B_in["x"],
        "B_w_gate": _B_in["w_gate"],
        "B_w_up": _B_in["w_up"],
        "B_w_down": _B_in["w_down"],
    }

def reference(A_x, A_wqkv, A_wo, B_x, B_w_gate, B_w_up, B_w_down):
    def _A_ref(x, wqkv, wo):
        B, S, D = x.shape
        H = 16
        Dh = D // H
        qkv = (lambda x, *d: x.permute(*d))((x @ wqkv).reshape(B, S, 3, H, Dh), 2, 0, 3, 1, 4)
        q, k, v = qkv[0], qkv[1], qkv[2]
        scores = torch.einsum("bhqd,bhkd->bhqk", q, k) * (Dh ** -0.5)
        p = _softmax(scores, axis=-1)
        o = torch.einsum("bhqk,bhkd->bhqd", p, v)
        return (lambda x, *d: x.permute(*d))(o, 0, 2, 1, 3).reshape(B, S, D) @ wo

    def _B_ref(x, w_gate, w_up, w_down):
        g = _silu(x @ w_gate)
        u = x @ w_up
        return (g * u) @ w_down

    x = A_x
    xn = _layernorm(x, axis=-1)
    s = _A_ref(xn, A_wqkv, A_wo)
    g = _silu(_B_ref(xn, B_w_gate, B_w_up, B_w_down))
    return x + s * g
```

```asm
; @launch grid=(256,1,1) block=(256,1,1) lds=163840
.amdgcn_target "amdgcn-amd-amdhsa--gfx950"
.text
.globl recurrent_scan__mha_block__swiglu_ffn__prompt_kernel
.p2align 8
.type recurrent_scan__mha_block__swiglu_ffn__prompt_kernel,@function
recurrent_scan__mha_block__swiglu_ffn__prompt_kernel:
    s_cmp_ge_u32 s2, 0x100
    s_cbranch_scc1 END
    s_load_dwordx2 s[4:5], s[0:1], 0
    s_load_dwordx2 s[32:33], s[0:1], 72
    s_load_dwordx2 s[8:9], s[0:1], 8
    s_load_dwordx2 s[16:17], s[0:1], 32
    s_load_dwordx2 s[20:21], s[0:1], 40
    s_load_dwordx2 s[24:25], s[0:1], 48
    s_load_dwordx2 s[12:13], s[0:1], 16
    s_load_dwordx2 s[28:29], s[0:1], 56
    v_lshrrev_b32 v1, 6, v0
    v_and_b32 v0, 63, v0
    s_and_b32 s43, s2, 3
    v_readfirstlane_b32 s40, v1
    s_bfe_u32 s44, s2, 0x20003
    s_lshr_b32 s42, s2, 5
    s_lshl1_add_u32 s85, s44, s42
    s_mul_i32 s55, s85, 128
    s_sub_u32 s85, s55, 896
    s_cselect_b32 s55, s55, s85
    s_and_b32 s85, s2, 4
    s_lshl1_add_u32 s42, s85, s42
    s_lshl2_add_u32 s86, s42, s40
    s_mul_i32 s45, s40, 40896
    s_mul_i32 s87, s86, 28672
    v_lshrrev_b32 v128, 3, v0
    v_and_b32 v129, 7, v0
    v_lshrrev_b32 v130, 4, v0
    v_xor_b32 v129, v129, v130
    v_mul_u32_u24 v128, 896, v128
    v_lshl_add_u32 v128, v129, 4, v128
    v_add_u32 v248, s87, v128
    v_xor_b32 v249, 64, v248
    v_add_u32 v249, 6144, v249
    v_add_u32 v246, 12288, v248
    v_add_u32 v247, 12288, v249
    s_mov_b32 s6, 1835008
    s_mov_b32 s7, 0x20000
    s_mov_b32 s34, 33554432
    s_mov_b32 s35, 0x20000
    s_lshr_b32 s101, s2, 3
    s_lshl2_add_u32 s101, s101, s40
    s_mul_i32 s3, s101, 512
    s_cmp_ge_u32 s3, 0x9c00
    s_cbranch_scc1 WRET0
    s_add_u32 m0, s3, WPAD0-WPC0
    s_getpc_b64 s[100:101]
WPC0:
    s_add_u32 s100, s100, m0
    s_addc_u32 s101, s101, 0
    s_mov_b64 exec, 0
    s_setpc_b64 s[100:101]
WRET0:
    s_mov_b64 exec, -1
    s_waitcnt lgkmcnt(0)
    s_add_u32 m0, s45, 12224
    s_add_u32 s56, s55, 128
    s_cmp_eq_u32 s56, 896
    s_cselect_b32 s56, 0, s56
    buffer_load_dwordx4 v248, s[4:7], s55 offen offset:0 lds
    buffer_load_dwordx4 v249, s[4:7], s55 offen offset:1024 lds
    buffer_load_dwordx4 v246, s[4:7], s55 offen offset:2048 lds
    buffer_load_dwordx4 v247, s[4:7], s55 offen offset:3072 lds
    s_add_u32 m0, s45, 16320
    s_add_u32 s57, s56, 128
    s_cmp_eq_u32 s57, 896
    s_cselect_b32 s57, 0, s57
    buffer_load_dwordx4 v248, s[4:7], s56 offen offset:0 lds
    buffer_load_dwordx4 v249, s[4:7], s56 offen offset:1024 lds
    buffer_load_dwordx4 v246, s[4:7], s56 offen offset:2048 lds
    buffer_load_dwordx4 v247, s[4:7], s56 offen offset:3072 lds
    s_add_u32 m0, s45, 20416
    s_add_u32 s58, s57, 128
    s_cmp_eq_u32 s58, 896
    s_cselect_b32 s58, 0, s58
    buffer_load_dwordx4 v248, s[4:7], s57 offen offset:0 lds
    buffer_load_dwordx4 v249, s[4:7], s57 offen offset:1024 lds
    buffer_load_dwordx4 v246, s[4:7], s57 offen offset:2048 lds
    buffer_load_dwordx4 v247, s[4:7], s57 offen offset:3072 lds
    s_add_u32 m0, s45, 24512
    s_add_u32 s59, s58, 128
WPAD0:
    s_cbranch_execz WRET0
    s_cmp_eq_u32 s59, 896
    s_cselect_b32 s59, 0, s59
    buffer_load_dwordx4 v248, s[4:7], s58 offen offset:0 lds
    buffer_load_dwordx4 v249, s[4:7], s58 offen offset:1024 lds
    buffer_load_dwordx4 v246, s[4:7], s58 offen offset:2048 lds
    buffer_load_dwordx4 v247, s[4:7], s58 offen offset:3072 lds
    s_add_u32 m0, s45, 28608
    s_add_u32 s60, s59, 128
    s_cmp_eq_u32 s60, 896
    s_cselect_b32 s60, 0, s60
    buffer_load_dwordx4 v248, s[4:7], s59 offen offset:0 lds
    buffer_load_dwordx4 v249, s[4:7], s59 offen offset:1024 lds
    buffer_load_dwordx4 v246, s[4:7], s59 offen offset:2048 lds
    buffer_load_dwordx4 v247, s[4:7], s59 offen offset:3072 lds
    s_add_u32 m0, s45, 32704
    s_add_u32 s61, s60, 128
    s_cmp_eq_u32 s61, 896
    s_cselect_b32 s61, 0, s61
    buffer_load_dwordx4 v248, s[4:7], s60 offen offset:0 lds
    buffer_load_dwordx4 v249, s[4:7], s60 offen offset:1024 lds
    buffer_load_dwordx4 v246, s[4:7], s60 offen offset:2048 lds
    buffer_load_dwordx4 v247, s[4:7], s60 offen offset:3072 lds
    s_add_u32 m0, s45, 36800
    s_mov_b32 s39, 0x20000
    buffer_load_dwordx4 v248, s[4:7], s61 offen offset:0 lds
    buffer_load_dwordx4 v249, s[4:7], s61 offen offset:1024 lds
    buffer_load_dwordx4 v246, s[4:7], s61 offen offset:2048 lds
    buffer_load_dwordx4 v247, s[4:7], s61 offen offset:3072 lds
    s_mov_b32 s10, 1204224
    s_mov_b32 s11, 0x20000
    s_mov_b32 s18, 1605632
    s_mov_b32 s19, 0x20000
    s_mov_b32 s22, 1605632
    s_mov_b32 s23, 0x20000
    s_mov_b32 s26, 401408
    s_mov_b32 s27, 0x20000
    s_mov_b32 s14, 401408
    s_mov_b32 s15, 0x20000
    s_mov_b32 s30, 1835008
    s_mov_b32 s31, 0x20000
    s_mov_b32 s38, 1605632
    buffer_load_dword v131, off, s[32:35], 0 sc1
    s_mul_i32 s48, s55, 1344
    s_mul_i32 s55, s55, 1792
    s_mul_i32 s49, s56, 1344
    s_mul_i32 s56, s56, 1792
    s_mul_i32 s50, s57, 1344
    s_mul_i32 s57, s57, 1792
    s_mul_i32 s51, s58, 1344
    s_mul_i32 s58, s58, 1792
    s_mul_i32 s52, s59, 1344
    s_mul_i32 s59, s59, 1792
    s_mul_i32 s53, s60, 1344
    s_mul_i32 s60, s60, 1792
    s_mul_i32 s54, s61, 1344
    s_mul_i32 s61, s61, 1792
    s_lshr_b32 s85, s44, 1
    s_lshr_b32 s87, s43, 1
    s_xor_b32 s87, s87, s85
    s_xor_b32 s87, s87, s44
    s_and_b32 s87, s87, 1
    s_lshl1_add_u32 s87, s85, s87
    s_lshl2_add_u32 s41, s43, s87
    s_lshl2_add_u32 s3, s43, s44
    v_lshlrev_b32 v1, 4, v0
    v_and_b32 v132, 3, v0
    v_lshrrev_b32 v134, 2, v0
    s_mul_i32 s87, s40, 43008
    s_mul_i32 s88, s41, 56
    s_add_u32 s87, s87, s88
    v_lshlrev_b32 v135, 4, v132
    v_mul_u32_u24 v11, 2688, v134
WPAD1:
    s_cbranch_execz WRET0
    v_add3_u32 v11, v11, v135, s87
    v_add_u32 v12, 768, v11
    s_mul_i32 s87, s40, 3584
    s_mul_i32 s88, s3, 224
    s_add_u32 s87, s87, s88
    v_mul_u32_u24 v137, 37, v0
    v_lshrrev_b32 v137, 9, v137
    v_mul_u32_u24 v7, 14112, v137
    v_add3_u32 v7, v7, v1, s87
    v_add_u32 v6, 56448, v7
    v_add_u32 v13, 112896, v7
    v_add_u32 v8, 169344, v7
    s_add_u32 m0, s45, 0
    s_nop 0
    buffer_load_dwordx4 v11, s[8:11], s48 offen lds
    buffer_load_dwordx4 v12, s[8:11], s48 offen offset:1024 lds
    s_add_u32 m0, s45, 1152
    s_nop 0
    buffer_load_dwordx4 v11, s[8:11], s48 offen offset:896 lds
    s_add_u32 m0, s45, 3072
    s_nop 0
    buffer_load_dwordx4 v7, s[16:19], s55 offen offset:0 lds
    buffer_load_dwordx4 v6, s[16:19], s55 offen offset:896 lds
    buffer_load_dwordx4 v13, s[16:19], s55 offen offset:1792 lds
    buffer_load_dwordx4 v8, s[16:19], s55 offen offset:2688 lds
    s_mul_i32 s85, s43, 401408
    s_add_u32 s24, s24, s85
    s_addc_u32 s25, s25, 0
    s_lshl_b32 s85, s41, 6
    s_add_u32 s87, s85, s86
    s_lshl_b32 s66, s87, 12
    s_add_u32 s66, s66, 65536
    s_lshl2_add_u32 s67, s87, 4096
    s_lshl4_add_u32 s87, s40, s85
    s_lshl2_add_u32 s68, s87, 4096
    s_lshl_b32 s69, s87, 12
    s_add_u32 s69, s69, 65536
    s_lshl4_add_u32 s87, s86, s41
    s_lshl2_add_u32 s80, s87, 16384
    s_lshl_b32 s79, s87, 11
    s_add_u32 s79, s79, 28377088
    s_lshl4_add_u32 s87, s86, s3
    s_mul_i32 s70, s87, 7168
    s_add_u32 s70, s70, 4259840
    s_add_u32 s71, s70, 4096
    s_lshl2_add_u32 s72, s87, 8192
    s_sub_u32 s87, s87, s44
    s_lshl2_add_u32 s73, s87, 8192
    s_mul_i32 s74, s87, 7168
    s_add_u32 s74, s74, 4259840
    s_lshl2_add_u32 s87, s86, s44
    s_lshl2_add_u32 s88, s87, s43
    s_lshl2_add_u32 s76, s88, 12288
    s_lshl4_add_u32 s88, s87, s43
    s_lshl_b32 s75, s88, 12
    s_add_u32 s75, s75, 11599872
    s_lshl2_add_u32 s85, s42, s43
    s_lshl2_add_u32 s87, s85, s44
    s_lshl4_add_u32 s77, s87, 12288
    s_lshl2_add_u32 s87, s87, s40
    s_lshl_b32 s78, s87, 14
    s_add_u32 s78, s78, 11599872
    s_lshl2_add_u32 s87, s85, s40
    s_lshl4_add_u32 s81, s87, 16384
    s_lshl_b32 s82, s87, 13
    s_add_u32 s82, s82, 28377088
    s_add_u32 s83, s82, 4096
    s_add_u32 s89, s40, 1
    s_and_b32 s89, s89, 3
    s_mul_i32 s89, s89, 40896
    s_xor_b32 s92, s40, 2
    s_mul_i32 s92, s92, 40896
    s_add_u32 s84, s40, 3
    s_and_b32 s84, s84, 3
    s_mul_i32 s84, s84, 40896
    s_mov_b32 s64, 0
    s_mov_b32 s65, 0
    s_mov_b32 s94, 0
    s_mov_b32 s95, -1
    s_mov_b32 s96, 0x10000000
    s_mov_b32 s97, 0x10000000
    v_lshrrev_b32 v128, 5, v0
    v_and_b32 v134, 31, v0
WPAD2:
    s_cbranch_execz WRET0
    v_lshrrev_b32 v135, 3, v134
    v_lshlrev_b32 v135, 10, v135
    v_and_b32 v136, 7, v0
    v_lshl_add_u32 v135, v136, 7, v135
    v_bfe_u32 v136, v0, 1, 3
    v_xor_b32 v136, v136, v128
    s_add_u32 s87, s45, 12224
    s_movk_i32 s88, 0x60
    v_lshl_add_u32 v135, v136, 4, v135
    v_add_u32 v250, s87, v135
    v_xad_u32 v251, v135, 32, s87
    v_xad_u32 v252, v135, 64, s87
    v_xor_b32 v253, s88, v135
    v_add_u32 v253, s87, v253
    v_bfe_u32 v129, v0, 2, 2
    v_mul_u32_u24 v5, 40896, v129
    v_lshl_add_u32 v129, v128, 3, v129
    v_bfe_u32 v130, v0, 4, 1
    v_lshlrev_b32 v133, 3, v132
    v_lshl_add_u32 v133, v130, 5, v133
    v_lshl_add_u32 v2, v129, 6, v133
    v_add_u32 v3, 57344, v2
    v_add_u32 v4, 114688, v2
    v_add_u32 v5, v5, v133
    v_mul_u32_u24 v129, 224, v128
    v_add_u32 v5, v5, v129
    v_accvgpr_write_b32 a253, v5
    v_add_u32 v5, v5, v129
    s_mul_i32 s87, s40, 896
    s_mul_i32 s88, s44, 224
    s_add_u32 s87, s87, s88
    v_mul_u32_u24 v137, 3360, v137
    v_add3_u32 v137, v137, v1, s87
    v_accvgpr_write_b32 a252, v137
    s_lshl2_add_u32 s87, s42, s43
    s_mul_i32 s87, s87, 28672
    s_add_u32 s87, s87, s88
    s_mul_i32 s88, s40, 56
    s_add_u32 s87, s87, s88
    v_mul_u32_u24 v134, 896, v134
    v_lshlrev_b32 v135, 3, v128
    v_add3_u32 v134, v134, v135, s87
    v_lshl_or_b32 v135, v128, 31, v134
    v_accvgpr_write_b32 a254, v134
    v_accvgpr_write_b32 a255, v135
    v_and_b32 v14, 15, v0
    v_lshlrev_b32 v14, 2, v14
    v_mov_b32 v15, 0x3f803f80
    v_mov_b32 v254, 0
    v_mov_b32 v255, 0
    s_mov_b32 s90, 0x3e0622e6
    s_mov_b32 s91, 0x3fb8aa3b
    s_lshr_b32 s87, s2, 3
    s_lshl2_add_u32 s63, s87, s40
    s_mul_i32 s63, s63, 3200
    s_lshr_b32 s88, s40, 1
    s_lshl1_add_u32 s87, s87, s88
    s_mul_i32 s88, s87, 25088
    s_mul_i32 s62, s43, 896
    s_add_u32 s88, s88, s62
    s_mul_i32 s87, s87, 6272
    s_bitcmp1_b32 s40, 0
    s_cselect_b32 s36, s20, s24
    s_cselect_b32 s37, s21, s25
    s_cselect_b32 s38, s22, s26
    s_cselect_b32 s87, s88, s87
    s_cselect_b32 s88, 2688, 0
    v_mul_u32_u24 v134, 37, v0
    v_lshrrev_b32 v134, 8, v134
    v_mul_u32_u24 v134, s88, v134
    v_lshl_add_u32 v134, v0, 7, v134
    v_cmp_gt_u32 vcc, 49, v0
    v_add_u32_e64 v134, s87, v134
    v_bfrev_b32 v136, 1
    v_cndmask_b32 v232, v136, v134, vcc
    v_cmp_gt_u32 vcc, 25, v0
    v_lshl_add_u32 v134, v0, 7, s63
    s_nop 0
    v_cndmask_b32 v233, v136, v134, vcc
    s_waitcnt vmcnt(32)
    ds_read_b128 v[16:19], v250 offset:0
    ds_read_b128 v[20:23], v251 offset:0
    ds_read_b128 v[24:27], v252 offset:0
    ds_read_b128 v[28:31], v253 offset:0
    s_waitcnt vmcnt(28)
WPAD3:
    s_cbranch_execz WRET0
    ds_read_b128 v[32:35], v250 offset:4096
    ds_read_b128 v[36:39], v251 offset:4096
    ds_read_b128 v[40:43], v252 offset:4096
    ds_read_b128 v[44:47], v253 offset:4096
    s_waitcnt lgkmcnt(7)
    v_dot2c_f32_bf16 v254, v16, v15
    v_lshlrev_b32 v176, 16, v16
    v_dot2c_f32_bf16 v255, v16, v16
    v_and_b32 v16, 0xffff0000, v16
    v_dot2c_f32_bf16 v254, v17, v15
    v_lshlrev_b32 v177, 16, v17
    v_dot2c_f32_bf16 v255, v17, v17
    v_and_b32 v17, 0xffff0000, v17
    v_dot2c_f32_bf16 v254, v18, v15
    v_lshlrev_b32 v178, 16, v18
    v_dot2c_f32_bf16 v255, v18, v18
    v_and_b32 v18, 0xffff0000, v18
    v_dot2c_f32_bf16 v254, v19, v15
    v_lshlrev_b32 v179, 16, v19
    v_dot2c_f32_bf16 v255, v19, v19
    v_and_b32 v19, 0xffff0000, v19
    s_waitcnt lgkmcnt(6)
    v_dot2c_f32_bf16 v254, v20, v15
    v_lshlrev_b32 v180, 16, v20
    v_dot2c_f32_bf16 v255, v20, v20
    v_and_b32 v20, 0xffff0000, v20
    v_dot2c_f32_bf16 v254, v21, v15
    v_lshlrev_b32 v181, 16, v21
    v_dot2c_f32_bf16 v255, v21, v21
    v_and_b32 v21, 0xffff0000, v21
    v_dot2c_f32_bf16 v254, v22, v15
    v_lshlrev_b32 v182, 16, v22
    v_dot2c_f32_bf16 v255, v22, v22
    v_and_b32 v22, 0xffff0000, v22
    v_dot2c_f32_bf16 v254, v23, v15
    v_lshlrev_b32 v183, 16, v23
    v_dot2c_f32_bf16 v255, v23, v23
    v_and_b32 v23, 0xffff0000, v23
    s_waitcnt lgkmcnt(5)
    v_dot2c_f32_bf16 v254, v24, v15
    v_lshlrev_b32 v184, 16, v24
    v_dot2c_f32_bf16 v255, v24, v24
    v_and_b32 v24, 0xffff0000, v24
    v_dot2c_f32_bf16 v254, v25, v15
    v_lshlrev_b32 v185, 16, v25
    v_dot2c_f32_bf16 v255, v25, v25
    v_and_b32 v25, 0xffff0000, v25
    v_dot2c_f32_bf16 v254, v26, v15
    v_lshlrev_b32 v186, 16, v26
    v_dot2c_f32_bf16 v255, v26, v26
    v_and_b32 v26, 0xffff0000, v26
    v_dot2c_f32_bf16 v254, v27, v15
    v_lshlrev_b32 v187, 16, v27
    v_dot2c_f32_bf16 v255, v27, v27
    v_and_b32 v27, 0xffff0000, v27
    s_waitcnt lgkmcnt(4)
    v_dot2c_f32_bf16 v254, v28, v15
    v_lshlrev_b32 v188, 16, v28
    v_dot2c_f32_bf16 v255, v28, v28
    v_and_b32 v28, 0xffff0000, v28
    v_dot2c_f32_bf16 v254, v29, v15
    v_lshlrev_b32 v189, 16, v29
    v_dot2c_f32_bf16 v255, v29, v29
    v_and_b32 v29, 0xffff0000, v29
    v_dot2c_f32_bf16 v254, v30, v15
    v_lshlrev_b32 v190, 16, v30
    v_dot2c_f32_bf16 v255, v30, v30
    v_and_b32 v30, 0xffff0000, v30
    v_dot2c_f32_bf16 v254, v31, v15
    v_lshlrev_b32 v191, 16, v31
    v_dot2c_f32_bf16 v255, v31, v31
    v_and_b32 v31, 0xffff0000, v31
    s_waitcnt vmcnt(24)
    ds_read_b128 v[48:51], v250 offset:8192
    ds_read_b128 v[52:55], v251 offset:8192
    ds_read_b128 v[56:59], v252 offset:8192
    ds_read_b128 v[60:63], v253 offset:8192
    s_waitcnt lgkmcnt(7)
    v_dot2c_f32_bf16 v254, v32, v15
    v_lshlrev_b32 v192, 16, v32
    v_dot2c_f32_bf16 v255, v32, v32
    v_and_b32 v32, 0xffff0000, v32
    v_dot2c_f32_bf16 v254, v33, v15
    v_lshlrev_b32 v193, 16, v33
    v_dot2c_f32_bf16 v255, v33, v33
    v_and_b32 v33, 0xffff0000, v33
    v_dot2c_f32_bf16 v254, v34, v15
    v_lshlrev_b32 v194, 16, v34
    v_dot2c_f32_bf16 v255, v34, v34
    v_and_b32 v34, 0xffff0000, v34
    v_dot2c_f32_bf16 v254, v35, v15
    v_lshlrev_b32 v195, 16, v35
    v_dot2c_f32_bf16 v255, v35, v35
    v_and_b32 v35, 0xffff0000, v35
    s_waitcnt lgkmcnt(6)
    v_dot2c_f32_bf16 v254, v36, v15
    v_lshlrev_b32_e64 v196, 16, v36
    v_dot2c_f32_bf16 v255, v36, v36
WPAD4:
    s_cbranch_execz WRET0
    v_and_b32 v36, 0xffff0000, v36
    v_dot2c_f32_bf16 v254, v37, v15
    v_lshlrev_b32 v197, 16, v37
    v_dot2c_f32_bf16 v255, v37, v37
    v_and_b32 v37, 0xffff0000, v37
    v_dot2c_f32_bf16 v254, v38, v15
    v_lshlrev_b32 v198, 16, v38
    v_dot2c_f32_bf16 v255, v38, v38
    v_and_b32 v38, 0xffff0000, v38
    v_dot2c_f32_bf16 v254, v39, v15
    v_lshlrev_b32 v199, 16, v39
    v_dot2c_f32_bf16 v255, v39, v39
    v_and_b32 v39, 0xffff0000, v39
    s_waitcnt lgkmcnt(5)
    v_dot2c_f32_bf16 v254, v40, v15
    v_lshlrev_b32 v200, 16, v40
    v_dot2c_f32_bf16 v255, v40, v40
    v_and_b32 v40, 0xffff0000, v40
    v_dot2c_f32_bf16 v254, v41, v15
    v_lshlrev_b32 v201, 16, v41
    v_dot2c_f32_bf16 v255, v41, v41
    v_and_b32 v41, 0xffff0000, v41
    v_dot2c_f32_bf16 v254, v42, v15
    v_lshlrev_b32 v202, 16, v42
    v_dot2c_f32_bf16 v255, v42, v42
    v_and_b32 v42, 0xffff0000, v42
    v_dot2c_f32_bf16 v254, v43, v15
    v_lshlrev_b32 v203, 16, v43
    v_dot2c_f32_bf16 v255, v43, v43
    v_and_b32 v43, 0xffff0000, v43
    s_waitcnt lgkmcnt(4)
    v_dot2c_f32_bf16 v254, v44, v15
    v_lshlrev_b32 v204, 16, v44
    v_dot2c_f32_bf16 v255, v44, v44
    v_and_b32 v44, 0xffff0000, v44
    v_dot2c_f32_bf16 v254, v45, v15
    v_lshlrev_b32 v205, 16, v45
    v_dot2c_f32_bf16 v255, v45, v45
    v_and_b32 v45, 0xffff0000, v45
    v_dot2c_f32_bf16 v254, v46, v15
    v_lshlrev_b32 v206, 16, v46
    v_dot2c_f32_bf16 v255, v46, v46
    v_and_b32 v46, 0xffff0000, v46
    v_dot2c_f32_bf16 v254, v47, v15
    v_lshlrev_b32 v207, 16, v47
    v_dot2c_f32_bf16 v255, v47, v47
    v_and_b32 v47, 0xffff0000, v47
    s_waitcnt vmcnt(20)
    ds_read_b128 v[64:67], v250 offset:12288
    ds_read_b128 v[68:71], v251 offset:12288
    ds_read_b128 v[72:75], v252 offset:12288
    ds_read_b128 v[76:79], v253 offset:12288
    s_waitcnt lgkmcnt(7)
    v_dot2c_f32_bf16 v254, v48, v15
    v_lshlrev_b32 v208, 16, v48
    v_dot2c_f32_bf16 v255, v48, v48
    v_and_b32 v48, 0xffff0000, v48
    v_dot2c_f32_bf16 v254, v49, v15
    v_lshlrev_b32 v209, 16, v49
    v_dot2c_f32_bf16 v255, v49, v49
    v_and_b32 v49, 0xffff0000, v49
    v_dot2c_f32_bf16 v254, v50, v15
    v_lshlrev_b32 v210, 16, v50
    v_dot2c_f32_bf16 v255, v50, v50
    v_and_b32 v50, 0xffff0000, v50
    v_dot2c_f32_bf16 v254, v51, v15
    v_lshlrev_b32 v211, 16, v51
    v_dot2c_f32_bf16 v255, v51, v51
    v_and_b32 v51, 0xffff0000, v51
    s_waitcnt lgkmcnt(6)
    v_dot2c_f32_bf16 v254, v52, v15
    v_lshlrev_b32 v212, 16, v52
    v_dot2c_f32_bf16 v255, v52, v52
    v_and_b32 v52, 0xffff0000, v52
    v_dot2c_f32_bf16 v254, v53, v15
    v_lshlrev_b32 v213, 16, v53
    v_dot2c_f32_bf16 v255, v53, v53
    v_and_b32 v53, 0xffff0000, v53
    v_dot2c_f32_bf16 v254, v54, v15
    v_lshlrev_b32 v214, 16, v54
    v_dot2c_f32_bf16 v255, v54, v54
    v_and_b32 v54, 0xffff0000, v54
    v_dot2c_f32_bf16 v254, v55, v15
    v_lshlrev_b32 v215, 16, v55
    v_dot2c_f32_bf16 v255, v55, v55
    v_and_b32 v55, 0xffff0000, v55
    s_waitcnt lgkmcnt(5)
    v_dot2c_f32_bf16 v254, v56, v15
    v_lshlrev_b32 v216, 16, v56
    v_dot2c_f32_bf16 v255, v56, v56
    v_and_b32 v56, 0xffff0000, v56
    v_dot2c_f32_bf16 v254, v57, v15
    v_lshlrev_b32 v217, 16, v57
    v_dot2c_f32_bf16 v255, v57, v57
    v_and_b32 v57, 0xffff0000, v57
    v_dot2c_f32_bf16 v254, v58, v15
    v_lshlrev_b32 v218, 16, v58
    v_dot2c_f32_bf16 v255, v58, v58
    v_and_b32 v58, 0xffff0000, v58
    v_dot2c_f32_bf16 v254, v59, v15
WPAD5:
    s_cbranch_execz WRET0
    v_lshlrev_b32 v219, 16, v59
    v_dot2c_f32_bf16 v255, v59, v59
    v_and_b32 v59, 0xffff0000, v59
    s_waitcnt lgkmcnt(4)
    v_dot2c_f32_bf16 v254, v60, v15
    v_lshlrev_b32 v220, 16, v60
    v_dot2c_f32_bf16 v255, v60, v60
    v_and_b32 v60, 0xffff0000, v60
    v_dot2c_f32_bf16 v254, v61, v15
    v_lshlrev_b32 v221, 16, v61
    v_dot2c_f32_bf16 v255, v61, v61
    v_and_b32 v61, 0xffff0000, v61
    v_dot2c_f32_bf16 v254, v62, v15
    v_lshlrev_b32 v222, 16, v62
    v_dot2c_f32_bf16 v255, v62, v62
    v_and_b32 v62, 0xffff0000, v62
    v_dot2c_f32_bf16 v254, v63, v15
    v_lshlrev_b32 v223, 16, v63
    v_dot2c_f32_bf16 v255, v63, v63
    v_and_b32 v63, 0xffff0000, v63
    s_waitcnt vmcnt(16)
    ds_read_b128 v[80:83], v250 offset:16384
    ds_read_b128 v[84:87], v251 offset:16384
    ds_read_b128 v[88:91], v252 offset:16384
    ds_read_b128 v[92:95], v253 offset:16384
    s_waitcnt lgkmcnt(7)
    v_dot2c_f32_bf16 v254, v64, v15
    v_lshlrev_b32 v224, 16, v64
    v_dot2c_f32_bf16 v255, v64, v64
    v_and_b32 v64, 0xffff0000, v64
    v_dot2c_f32_bf16 v254, v65, v15
    v_lshlrev_b32 v225, 16, v65
    v_dot2c_f32_bf16 v255, v65, v65
    v_and_b32 v65, 0xffff0000, v65
    v_dot2c_f32_bf16 v254, v66, v15
    v_lshlrev_b32 v226, 16, v66
    v_dot2c_f32_bf16 v255, v66, v66
    v_and_b32 v66, 0xffff0000, v66
    v_dot2c_f32_bf16 v254, v67, v15
    v_lshlrev_b32 v227, 16, v67
    v_dot2c_f32_bf16 v255, v67, v67
    v_and_b32 v67, 0xffff0000, v67
    s_waitcnt lgkmcnt(6)
    v_dot2c_f32_bf16 v254, v68, v15
    v_lshlrev_b32 v228, 16, v68
    v_dot2c_f32_bf16 v255, v68, v68
    v_and_b32 v68, 0xffff0000, v68
    v_dot2c_f32_bf16 v254, v69, v15
    v_lshlrev_b32 v229, 16, v69
    v_dot2c_f32_bf16 v255, v69, v69
    v_and_b32 v69, 0xffff0000, v69
    v_dot2c_f32_bf16 v254, v70, v15
    v_lshlrev_b32 v230, 16, v70
    v_dot2c_f32_bf16 v255, v70, v70
    v_and_b32 v70, 0xffff0000, v70
    v_dot2c_f32_bf16 v254, v71, v15
    v_lshlrev_b32 v231, 16, v71
    v_dot2c_f32_bf16 v255, v71, v71
    v_and_b32 v71, 0xffff0000, v71
    s_waitcnt lgkmcnt(5)
    v_dot2c_f32_bf16 v254, v72, v15
    v_dot2c_f32_bf16 v255, v72, v72
    v_dot2c_f32_bf16 v254, v73, v15
    v_dot2c_f32_bf16 v255, v73, v73
    v_dot2c_f32_bf16 v254, v74, v15
    v_dot2c_f32_bf16 v255, v74, v74
    v_dot2c_f32_bf16 v254, v75, v15
    v_dot2c_f32_bf16 v255, v75, v75
    s_waitcnt lgkmcnt(4)
    v_dot2c_f32_bf16 v254, v76, v15
    v_dot2c_f32_bf16 v255, v76, v76
    v_dot2c_f32_bf16 v254, v77, v15
    v_dot2c_f32_bf16 v255, v77, v77
    v_dot2c_f32_bf16 v254, v78, v15
    v_dot2c_f32_bf16 v255, v78, v78
    v_dot2c_f32_bf16 v254, v79, v15
    v_dot2c_f32_bf16 v255, v79, v79
    s_waitcnt vmcnt(12)
    ds_read_b128 v[96:99], v250 offset:20480
    ds_read_b128 v[100:103], v251 offset:20480
    ds_read_b128 v[104:107], v252 offset:20480
    ds_read_b128 v[108:111], v253 offset:20480
    s_waitcnt lgkmcnt(7)
    v_dot2c_f32_bf16 v254, v80, v15
    v_dot2c_f32_bf16 v255, v80, v80
    v_dot2c_f32_bf16 v254, v81, v15
    v_dot2c_f32_bf16 v255, v81, v81
    v_dot2c_f32_bf16 v254, v82, v15
    v_dot2c_f32_bf16 v255, v82, v82
    v_dot2c_f32_bf16 v254, v83, v15
    v_dot2c_f32_bf16 v255, v83, v83
    s_waitcnt lgkmcnt(6)
    v_dot2c_f32_bf16 v254, v84, v15
    v_dot2c_f32_bf16 v255, v84, v84
    v_dot2c_f32_bf16 v254, v85, v15
    v_dot2c_f32_bf16 v255, v85, v85
    v_dot2c_f32_bf16 v254, v86, v15
    v_dot2c_f32_bf16 v255, v86, v86
    v_dot2c_f32_bf16 v254, v87, v15
    v_dot2c_f32_bf16 v255, v87, v87
    s_waitcnt lgkmcnt(5)
    v_dot2c_f32_bf16 v254, v88, v15
    v_dot2c_f32_bf16 v255, v88, v88
    v_dot2c_f32_bf16 v254, v89, v15
    v_dot2c_f32_bf16 v255, v89, v89
    v_dot2c_f32_bf16 v254, v90, v15
WPAD6:
    s_cbranch_execz WRET0
    v_dot2c_f32_bf16 v255, v90, v90
    v_dot2c_f32_bf16 v254, v91, v15
    v_dot2c_f32_bf16 v255, v91, v91
    s_waitcnt lgkmcnt(4)
    v_dot2c_f32_bf16 v254, v92, v15
    v_dot2c_f32_bf16 v255, v92, v92
    v_dot2c_f32_bf16 v254, v93, v15
    v_dot2c_f32_bf16 v255, v93, v93
    v_dot2c_f32_bf16 v254, v94, v15
    v_dot2c_f32_bf16 v255, v94, v94
    v_dot2c_f32_bf16 v254, v95, v15
    v_dot2c_f32_bf16 v255, v95, v95
    s_waitcnt vmcnt(8)
    ds_read_b128 v[112:115], v250 offset:24576
    ds_read_b128 v[116:119], v251 offset:24576
    ds_read_b128 v[120:123], v252 offset:24576
    ds_read_b128 v[124:127], v253 offset:24576
    s_waitcnt lgkmcnt(7)
    v_dot2c_f32_bf16 v254, v96, v15
    v_dot2c_f32_bf16 v255, v96, v96
    v_dot2c_f32_bf16 v254, v97, v15
    v_dot2c_f32_bf16 v255, v97, v97
    v_dot2c_f32_bf16 v254, v98, v15
    v_dot2c_f32_bf16 v255, v98, v98
    v_dot2c_f32_bf16 v254, v99, v15
    v_dot2c_f32_bf16 v255, v99, v99
    s_waitcnt lgkmcnt(6)
    v_dot2c_f32_bf16 v254, v100, v15
    v_dot2c_f32_bf16 v255, v100, v100
    v_dot2c_f32_bf16 v254, v101, v15
    v_dot2c_f32_bf16 v255, v101, v101
    v_dot2c_f32_bf16 v254, v102, v15
    v_dot2c_f32_bf16 v255, v102, v102
    v_dot2c_f32_bf16 v254, v103, v15
    v_dot2c_f32_bf16 v255, v103, v103
    s_waitcnt lgkmcnt(5)
    v_dot2c_f32_bf16 v254, v104, v15
    v_dot2c_f32_bf16 v255, v104, v104
    v_dot2c_f32_bf16 v254, v105, v15
    v_dot2c_f32_bf16 v255, v105, v105
    v_dot2c_f32_bf16 v254, v106, v15
    v_dot2c_f32_bf16 v255, v106, v106
    v_dot2c_f32_bf16 v254, v107, v15
    v_dot2c_f32_bf16 v255, v107, v107
    s_waitcnt lgkmcnt(4)
    v_dot2c_f32_bf16 v254, v108, v15
    v_dot2c_f32_bf16 v255, v108, v108
    v_dot2c_f32_bf16 v254, v109, v15
    v_dot2c_f32_bf16 v255, v109, v109
    v_dot2c_f32_bf16 v254, v110, v15
    v_dot2c_f32_bf16 v255, v110, v110
    v_dot2c_f32_bf16 v254, v111, v15
    v_dot2c_f32_bf16 v255, v111, v111
    s_waitcnt lgkmcnt(0)
    s_add_u32 m0, s45, 6784
    s_nop 0
    buffer_load_dwordx4 v11, s[8:11], s49 offen lds
    buffer_load_dwordx4 v12, s[8:11], s49 offen offset:1024 lds
    s_add_u32 m0, s45, 7936
    s_nop 0
    buffer_load_dwordx4 v11, s[8:11], s49 offen offset:896 lds
    s_add_u32 m0, s45, 9856
    s_nop 0
    buffer_load_dwordx4 v7, s[16:19], s56 offen offset:0 lds
    buffer_load_dwordx4 v6, s[16:19], s56 offen offset:896 lds
    buffer_load_dwordx4 v13, s[16:19], s56 offen offset:1792 lds
    buffer_load_dwordx4 v8, s[16:19], s56 offen offset:2688 lds
    v_dot2c_f32_bf16 v254, v112, v15
    v_dot2c_f32_bf16 v255, v112, v112
    v_dot2c_f32_bf16 v254, v113, v15
    v_dot2c_f32_bf16 v255, v113, v113
    v_dot2c_f32_bf16 v254, v114, v15
    v_dot2c_f32_bf16 v255, v114, v114
    v_dot2c_f32_bf16 v254, v115, v15
    v_dot2c_f32_bf16 v255, v115, v115
    v_dot2c_f32_bf16 v254, v116, v15
    v_dot2c_f32_bf16 v255, v116, v116
    v_dot2c_f32_bf16 v254, v117, v15
    v_dot2c_f32_bf16 v255, v117, v117
    v_dot2c_f32_bf16 v254, v118, v15
    v_dot2c_f32_bf16 v255, v118, v118
    v_dot2c_f32_bf16 v254, v119, v15
    v_dot2c_f32_bf16 v255, v119, v119
    v_dot2c_f32_bf16 v254, v120, v15
    v_dot2c_f32_bf16 v255, v120, v120
    v_dot2c_f32_bf16 v254, v121, v15
    v_dot2c_f32_bf16 v255, v121, v121
    v_dot2c_f32_bf16 v254, v122, v15
    v_dot2c_f32_bf16 v255, v122, v122
    v_dot2c_f32_bf16 v254, v123, v15
    v_dot2c_f32_bf16 v255, v123, v123
    v_dot2c_f32_bf16 v254, v124, v15
    v_dot2c_f32_bf16 v255, v124, v124
    v_dot2c_f32_bf16 v254, v125, v15
    v_dot2c_f32_bf16 v255, v125, v125
    v_dot2c_f32_bf16 v254, v126, v15
    v_dot2c_f32_bf16 v255, v126, v126
    v_dot2c_f32_bf16 v254, v127, v15
    v_dot2c_f32_bf16 v255, v127, v127
    s_waitcnt vmcnt(14)
    v_readfirstlane_b32 s46, v131
    s_nop 0
    v_permlane32_swap_b32 v254, v255
    s_mul_i32 s46, s46, 0x9e3779b1
    s_add_u32 s46, s46, 0x7f4a7c15
    s_waitcnt vmcnt(7)
    s_barrier
    ds_read_b64_tr_b16 a[0:1], v2 offset:0
    ds_read_b64_tr_b16 a[2:3], v2 offset:256
WPAD7:
    s_cbranch_execz WRET0
    ds_read_b64_tr_b16 a[4:5], v2 offset:2048
    ds_read_b64_tr_b16 a[6:7], v2 offset:2304
    ds_read_b64_tr_b16 a[8:9], v2 offset:1024
    ds_read_b64_tr_b16 a[10:11], v2 offset:1280
    ds_read_b64_tr_b16 a[12:13], v5 offset:3072
    ds_read_b64_tr_b16 a[14:15], v5 offset:3296
    v_add_f32 v254, v254, v255
    v_mov_b32 v255, v254
    s_mov_b32 s87, 0x3b124925
    s_mov_b32 s88, 0x3727c5ac
    v_permlane32_swap_b32 v254, v255
    v_mul_f32 v254, s87, v254
    v_mul_f32 v255, s87, v255
    v_fma_f32 v255, -v254, v254, v255
    v_max_f32 v255, 0, v255
    v_add_f32 v255, s88, v255
    v_rsq_f32 v255, v255
    s_nop 0
    v_mul_f32 v9, 0x3fb8aa3b, v255
    v_mul_f32 v10, v9, v254
    v_sub_f32_e64 v10, 0, v10
    v_fma_f32 v176, v176, v9, v10
    v_fma_f32 v16, v16, v9, v10
    v_cvt_pk_bf16_f32 v16, v176, v16
    v_fma_f32 v177, v177, v9, v10
    v_fma_f32 v17, v17, v9, v10
    v_cvt_pk_bf16_f32 v17, v177, v17
    v_fma_f32 v178, v178, v9, v10
    v_fma_f32 v18, v18, v9, v10
    v_cvt_pk_bf16_f32 v18, v178, v18
    v_fma_f32 v179, v179, v9, v10
    v_fma_f32 v19, v19, v9, v10
    v_cvt_pk_bf16_f32 v19, v179, v19
    s_waitcnt lgkmcnt(6)
    s_nop 0
    v_mfma_f32_32x32x16_bf16 v[128:143], a[0:3], v[16:19], 0
    s_waitcnt lgkmcnt(4)
    ds_read_b64_tr_b16 a[16:17], v5 offset:3136
    ds_read_b64_tr_b16 a[18:19], v5 offset:3360
    s_add_u32 m0, s45, 13568
    v_fma_f32 v180, v180, v9, v10
    v_fma_f32 v20, v20, v9, v10
    v_cvt_pk_bf16_f32 v20, v180, v20
    v_mfma_f32_32x32x16_bf16 v[144:159], a[4:7], v[16:19], 0
    s_waitcnt lgkmcnt(4)
    ds_read_b64_tr_b16 a[20:21], v5 offset:3200
    ds_read_b64_tr_b16 a[22:23], v5 offset:3424
    buffer_load_dwordx4 v11, s[8:11], s50 offen lds
    v_fma_f32 v181, v181, v9, v10
    v_fma_f32 v21, v21, v9, v10
    v_mfma_f32_32x32x16_bf16 v[160:175], v[16:19], a[8:11], 0
    s_waitcnt lgkmcnt(4)
    ds_read_b64_tr_b16 a[0:1], v5 offset:3264
    ds_read_b64_tr_b16 a[2:3], v5 offset:3488
    v_cvt_pk_bf16_f32 v21, v181, v21
    v_fma_f32 v182, v182, v9, v10
    v_fma_f32 v22, v22, v9, v10
    v_cvt_pk_bf16_f32 v22, v182, v22
    v_mfma_f32_32x32x16_bf16 a[128:143], a[12:15], v[16:19], 0
    s_waitcnt lgkmcnt(4)
    ds_read_b64_tr_b16 a[4:5], v2 offset:40896
    ds_read_b64_tr_b16 a[6:7], v2 offset:41152
    buffer_load_dwordx4 v12, s[8:11], s50 offen offset:1024 lds
    v_fma_f32 v183, v183, v9, v10
    v_fma_f32 v23, v23, v9, v10
    v_mfma_f32_32x32x16_bf16 a[144:159], a[16:19], v[16:19], 0
    s_waitcnt lgkmcnt(4)
    ds_read_b64_tr_b16 a[8:9], v2 offset:42944
    ds_read_b64_tr_b16 a[10:11], v2 offset:43200
    v_cvt_pk_bf16_f32 v23, v183, v23
    v_fma_f32 v184, v184, v9, v10
    v_fma_f32 v24, v24, v9, v10
WPAD8:
    s_cbranch_execz WRET0
    v_cvt_pk_bf16_f32 v24, v184, v24
    v_mfma_f32_32x32x16_bf16 a[160:175], a[20:23], v[16:19], 0
    s_waitcnt lgkmcnt(4)
    ds_read_b64_tr_b16 a[12:13], v2 offset:41920
    ds_read_b64_tr_b16 a[14:15], v2 offset:42176
    s_add_u32 m0, s45, 14720
    v_fma_f32 v185, v185, v9, v10
    v_fma_f32 v25, v25, v9, v10
    v_cvt_pk_bf16_f32 v25, v185, v25
    v_mfma_f32_32x32x16_bf16 a[176:191], a[0:3], v[16:19], 0
    s_waitcnt lgkmcnt(4)
    ds_read_b64_tr_b16 a[16:17], v5 offset:3968
    ds_read_b64_tr_b16 a[18:19], v5 offset:4192
    buffer_load_dwordx4 v11, s[8:11], s50 offen offset:896 lds
    v_fma_f32 v186, v186, v9, v10
    v_fma_f32 v26, v26, v9, v10
    v_mfma_f32_32x32x16_bf16 v[128:143], a[4:7], v[20:23], v[128:143]
    s_waitcnt lgkmcnt(4)
    ds_read_b64_tr_b16 a[20:21], v5 offset:4032
    ds_read_b64_tr_b16 a[22:23], v5 offset:4256
    v_cvt_pk_bf16_f32 v26, v186, v26
    v_fma_f32 v187, v187, v9, v10
    v_fma_f32 v27, v27, v9, v10
    v_cvt_pk_bf16_f32 v27, v187, v27
    v_mfma_f32_32x32x16_bf16 v[144:159], a[8:11], v[20:23], v[144:159]
    s_waitcnt lgkmcnt(4)
    ds_read_b64_tr_b16 a[0:1], v5 offset:4096
    ds_read_b64_tr_b16 a[2:3], v5 offset:4320
    s_add_u32 m0, s45, 16640
    v_fma_f32 v188, v188, v9, v10
    v_fma_f32 v28, v28, v9, v10
    v_cvt_pk_bf16_f32 v28, v188, v28
    v_mfma_f32_32x32x16_bf16 v[160:175], v[20:23], a[12:15], v[160:175]
    s_waitcnt lgkmcnt(4)
    ds_read_b64_tr_b16 a[4:5], v5 offset:4160
    ds_read_b64_tr_b16 a[6:7], v5 offset:4384
    buffer_load_dwordx4 v7, s[16:19], s57 offen offset:0 lds
    v_fma_f32 v189, v189, v9, v10
    v_fma_f32 v29, v29, v9, v10
    v_mfma_f32_32x32x16_bf16 a[128:143], a[16:19], v[20:23], a[128:143]
    s_waitcnt lgkmcnt(4)
    ds_read_b64_tr_b16 a[8:9], v3 offset:24448
    ds_read_b64_tr_b16 a[10:11], v3 offset:24704
    v_cvt_pk_bf16_f32 v29, v189, v29
    v_fma_f32 v190, v190, v9, v10
    v_fma_f32 v30, v30, v9, v10
    v_cvt_pk_bf16_f32 v30, v190, v30
    v_mfma_f32_32x32x16_bf16 a[144:159], a[20:23], v[20:23], a[144:159]
    s_waitcnt lgkmcnt(4)
    ds_read_b64_tr_b16 a[12:13], v3 offset:26496
    ds_read_b64_tr_b16 a[14:15], v3 offset:26752
    v_fma_f32 v191, v191, v9, v10
    v_fma_f32 v31, v31, v9, v10
    v_cvt_pk_bf16_f32 v31, v191, v31
    v_fma_f32 v192, v192, v9, v10
    v_mfma_f32_32x32x16_bf16 a[160:175], a[0:3], v[20:23], a[160:175]
    s_waitcnt lgkmcnt(4)
    ds_read_b64_tr_b16 a[16:17], v3 offset:25472
    ds_read_b64_tr_b16 a[18:19], v3 offset:25728
    buffer_load_dwordx4 v6, s[16:19], s57 offen offset:896 lds
    v_fma_f32 v32, v32, v9, v10
    v_cvt_pk_bf16_f32 v32, v192, v32
    v_mfma_f32_32x32x16_bf16 a[176:191], a[4:7], v[20:23], a[176:191]
    s_waitcnt lgkmcnt(4)
    ds_read_b64_tr_b16 a[20:21], v5 offset:4864
    ds_read_b64_tr_b16 a[22:23], v5 offset:5088
    v_fma_f32 v193, v193, v9, v10
    v_fma_f32 v33, v33, v9, v10
WPAD9:
    s_cbranch_execz WRET0
    v_cvt_pk_bf16_f32 v33, v193, v33
    v_fma_f32 v194, v194, v9, v10
    v_mfma_f32_32x32x16_bf16 v[128:143], a[8:11], v[24:27], v[128:143]
    s_waitcnt lgkmcnt(4)
    ds_read_b64_tr_b16 a[0:1], v5 offset:4928
    ds_read_b64_tr_b16 a[2:3], v5 offset:5152
    v_fma_f32 v34, v34, v9, v10
    v_cvt_pk_bf16_f32 v34, v194, v34
    v_fma_f32 v195, v195, v9, v10
    v_fma_f32 v35, v35, v9, v10
    v_mfma_f32_32x32x16_bf16 v[144:159], a[12:15], v[24:27], v[144:159]
    s_waitcnt lgkmcnt(4)
    ds_read_b64_tr_b16 a[4:5], v5 offset:4992
    ds_read_b64_tr_b16 a[6:7], v5 offset:5216
    buffer_load_dwordx4 v13, s[16:19], s57 offen offset:1792 lds
    v_cvt_pk_bf16_f32 v35, v195, v35
    v_fma_f32 v196, v196, v9, v10
    v_mfma_f32_32x32x16_bf16 v[160:175], v[24:27], a[16:19], v[160:175]
    s_waitcnt lgkmcnt(4)
    ds_read_b64_tr_b16 a[8:9], v5 offset:5056
    ds_read_b64_tr_b16 a[10:11], v5 offset:5280
    v_fma_f32 v36, v36, v9, v10
    v_cvt_pk_bf16_f32 v36, v196, v36
    v_fma_f32 v197, v197, v9, v10
    v_fma_f32 v37, v37, v9, v10
    v_mfma_f32_32x32x16_bf16 a[128:143], a[20:23], v[24:27], a[128:143]
    s_waitcnt lgkmcnt(4)
    ds_read_b64_tr_b16 a[12:13], v4 offset:8000
    ds_read_b64_tr_b16 a[14:15], v4 offset:8256
    v_cvt_pk_bf16_f32 v37, v197, v37
    v_fma_f32 v198, v198, v9, v10
    v_fma_f32 v38, v38, v9, v10
    v_cvt_pk_bf16_f32 v38, v198, v38
    v_mfma_f32_32x32x16_bf16 a[144:159], a[0:3], v[24:27], a[144:159]
    s_waitcnt lgkmcnt(4)
    ds_read_b64_tr_b16 a[16:17], v4 offset:10048
    ds_read_b64_tr_b16 a[18:19], v4 offset:10304
    buffer_load_dwordx4 v8, s[16:19], s57 offen offset:2688 lds
    v_fma_f32 v199, v199, v9, v10
    v_fma_f32 v39, v39, v9, v10
    v_mfma_f32_32x32x16_bf16 a[160:175], a[4:7], v[24:27], a[160:175]
    s_waitcnt lgkmcnt(4)
    ds_read_b64_tr_b16 a[20:21], v4 offset:9024
    ds_read_b64_tr_b16 a[22:23], v4 offset:9280
    v_cvt_pk_bf16_f32 v39, v199, v39
    v_fma_f32 v200, v200, v9, v10
    v_fma_f32 v40, v40, v9, v10
    v_cvt_pk_bf16_f32 v40, v200, v40
    v_mfma_f32_32x32x16_bf16 a[176:191], a[8:11], v[24:27], a[176:191]
    s_waitcnt lgkmcnt(4)
    ds_read_b64_tr_b16 a[0:1], v5 offset:5760
    ds_read_b64_tr_b16 a[2:3], v5 offset:5984
    s_add_u32 m0, s45, 20352
    v_fma_f32 v201, v201, v9, v10
    v_fma_f32 v41, v41, v9, v10
    v_cvt_pk_bf16_f32 v41, v201, v41
    v_mfma_f32_32x32x16_bf16 v[128:143], a[12:15], v[28:31], v[128:143]
    s_waitcnt lgkmcnt(4)
    ds_read_b64_tr_b16 a[4:5], v5 offset:5824
    ds_read_b64_tr_b16 a[6:7], v5 offset:6048
    buffer_load_dwordx4 v11, s[8:11], s51 offen lds
    v_fma_f32 v202, v202, v9, v10
    v_fma_f32 v42, v42, v9, v10
    v_mfma_f32_32x32x16_bf16 v[144:159], a[16:19], v[28:31], v[144:159]
    s_waitcnt lgkmcnt(4)
    ds_read_b64_tr_b16 a[8:9], v5 offset:5888
    ds_read_b64_tr_b16 a[10:11], v5 offset:6112
    v_cvt_pk_bf16_f32 v42, v202, v42
WPAD10:
    s_cbranch_execz WRET0
    v_fma_f32 v203, v203, v9, v10
    v_fma_f32 v43, v43, v9, v10
    v_cvt_pk_bf16_f32 v43, v203, v43
    v_mfma_f32_32x32x16_bf16 v[160:175], v[28:31], a[20:23], v[160:175]
    s_waitcnt lgkmcnt(4)
    ds_read_b64_tr_b16 a[12:13], v5 offset:5952
    ds_read_b64_tr_b16 a[14:15], v5 offset:6176
    v_fma_f32 v204, v204, v9, v10
    v_fma_f32 v44, v44, v9, v10
    v_cvt_pk_bf16_f32 v44, v204, v44
    v_fma_f32 v205, v205, v9, v10
    v_mfma_f32_32x32x16_bf16 a[128:143], a[0:3], v[28:31], a[128:143]
    s_waitcnt lgkmcnt(4)
    s_waitcnt vmcnt(8) lgkmcnt(0)
    s_barrier
    ds_read_b64_tr_b16 a[16:17], v2 offset:6784
    ds_read_b64_tr_b16 a[18:19], v2 offset:7040
    buffer_load_dwordx4 v12, s[8:11], s51 offen offset:1024 lds
    v_fma_f32 v45, v45, v9, v10
    v_cvt_pk_bf16_f32 v45, v205, v45
    v_mfma_f32_32x32x16_bf16 a[144:159], a[4:7], v[28:31], a[144:159]
    ds_read_b64_tr_b16 a[20:21], v2 offset:8832
    ds_read_b64_tr_b16 a[22:23], v2 offset:9088
    v_fma_f32 v206, v206, v9, v10
    v_fma_f32 v46, v46, v9, v10
    v_cvt_pk_bf16_f32 v46, v206, v46
    v_fma_f32 v207, v207, v9, v10
    v_mfma_f32_32x32x16_bf16 a[160:175], a[8:11], v[28:31], a[160:175]
    ds_read_b64_tr_b16 a[0:1], v2 offset:7808
    ds_read_b64_tr_b16 a[2:3], v2 offset:8064
    s_add_u32 m0, s45, 21504
    v_fma_f32 v47, v47, v9, v10
    v_cvt_pk_bf16_f32 v47, v207, v47
    v_fma_f32 v208, v208, v9, v10
    v_mfma_f32_32x32x16_bf16 a[176:191], a[12:15], v[28:31], a[176:191]
    s_waitcnt lgkmcnt(4)
    ds_read_b64_tr_b16 a[4:5], v5 offset:9856
    ds_read_b64_tr_b16 a[6:7], v5 offset:10080
    buffer_load_dwordx4 v11, s[8:11], s51 offen offset:896 lds
    v_fma_f32 v48, v48, v9, v10
    v_cvt_pk_bf16_f32 v48, v208, v48
    v_mfma_f32_32x32x16_bf16 v[128:143], a[16:19], v[32:35], v[128:143]
    s_waitcnt lgkmcnt(4)
    ds_read_b64_tr_b16 a[8:9], v5 offset:9920
    ds_read_b64_tr_b16 a[10:11], v5 offset:10144
    v_fma_f32 v209, v209, v9, v10
    v_fma_f32 v49, v49, v9, v10
    v_cvt_pk_bf16_f32 v49, v209, v49
    v_fma_f32 v210, v210, v9, v10
    v_mfma_f32_32x32x16_bf16 v[144:159], a[20:23], v[32:35], v[144:159]
    s_waitcnt lgkmcnt(4)
    ds_read_b64_tr_b16 a[12:13], v5 offset:9984
    ds_read_b64_tr_b16 a[14:15], v5 offset:10208
    s_add_u32 m0, s45, 23424
    v_fma_f32 v50, v50, v9, v10
    v_cvt_pk_bf16_f32 v50, v210, v50
    v_fma_f32 v211, v211, v9, v10
    v_mfma_f32_32x32x16_bf16 v[160:175], v[32:35], a[0:3], v[160:175]
    s_waitcnt lgkmcnt(4)
    ds_read_b64_tr_b16 a[16:17], v5 offset:10048
    ds_read_b64_tr_b16 a[18:19], v5 offset:10272
    buffer_load_dwordx4 v7, s[16:19], s58 offen offset:0 lds
    v_fma_f32 v51, v51, v9, v10
    v_cvt_pk_bf16_f32 v51, v211, v51
    v_mfma_f32_32x32x16_bf16 a[128:143], a[4:7], v[32:35], a[128:143]
    s_waitcnt lgkmcnt(4)
    ds_read_b64_tr_b16 a[20:21], v2 offset:47680
    ds_read_b64_tr_b16 a[22:23], v2 offset:47936
WPAD11:
    s_cbranch_execz WRET0
    v_fma_f32 v212, v212, v9, v10
    v_fma_f32 v52, v52, v9, v10
    v_cvt_pk_bf16_f32 v52, v212, v52
    v_fma_f32 v213, v213, v9, v10
    v_mfma_f32_32x32x16_bf16 a[144:159], a[8:11], v[32:35], a[144:159]
    s_waitcnt lgkmcnt(4)
    ds_read_b64_tr_b16 a[0:1], v2 offset:49728
    ds_read_b64_tr_b16 a[2:3], v2 offset:49984
    v_fma_f32 v53, v53, v9, v10
    v_cvt_pk_bf16_f32 v53, v213, v53
    v_fma_f32 v214, v214, v9, v10
    v_fma_f32 v54, v54, v9, v10
    v_mfma_f32_32x32x16_bf16 a[160:175], a[12:15], v[32:35], a[160:175]
    s_waitcnt lgkmcnt(4)
    ds_read_b64_tr_b16 a[4:5], v2 offset:48704
    ds_read_b64_tr_b16 a[6:7], v2 offset:48960
    buffer_load_dwordx4 v6, s[16:19], s58 offen offset:896 lds
    v_cvt_pk_bf16_f32 v54, v214, v54
    v_fma_f32 v215, v215, v9, v10
    v_mfma_f32_32x32x16_bf16 a[176:191], a[16:19], v[32:35], a[176:191]
    s_waitcnt lgkmcnt(4)
    ds_read_b64_tr_b16 a[8:9], v5 offset:10752
    ds_read_b64_tr_b16 a[10:11], v5 offset:10976
    v_fma_f32 v55, v55, v9, v10
    v_cvt_pk_bf16_f32 v55, v215, v55
    v_fma_f32 v216, v216, v9, v10
    v_fma_f32 v56, v56, v9, v10
    v_mfma_f32_32x32x16_bf16 v[128:143], a[20:23], v[36:39], v[128:143]
    s_waitcnt lgkmcnt(4)
    ds_read_b64_tr_b16 a[12:13], v5 offset:10816
    ds_read_b64_tr_b16 a[14:15], v5 offset:11040
    v_cvt_pk_bf16_f32 v56, v216, v56
    v_fma_f32 v217, v217, v9, v10
    v_fma_f32 v57, v57, v9, v10
    v_cvt_pk_bf16_f32 v57, v217, v57
    v_mfma_f32_32x32x16_bf16 v[144:159], a[0:3], v[36:39], v[144:159]
    s_waitcnt lgkmcnt(4)
    ds_read_b64_tr_b16 a[16:17], v5 offset:10880
    ds_read_b64_tr_b16 a[18:19], v5 offset:11104
    buffer_load_dwordx4 v13, s[16:19], s58 offen offset:1792 lds
    v_fma_f32 v218, v218, v9, v10
    v_fma_f32 v58, v58, v9, v10
    v_mfma_f32_32x32x16_bf16 v[160:175], v[36:39], a[4:7], v[160:175]
    s_waitcnt lgkmcnt(4)
    ds_read_b64_tr_b16 a[20:21], v5 offset:10944
    ds_read_b64_tr_b16 a[22:23], v5 offset:11168
    v_cvt_pk_bf16_f32 v58, v218, v58
    v_fma_f32 v219, v219, v9, v10
    v_fma_f32 v59, v59, v9, v10
    v_cvt_pk_bf16_f32 v59, v219, v59
    v_mfma_f32_32x32x16_bf16 a[128:143], a[8:11], v[36:39], a[128:143]
    s_waitcnt lgkmcnt(4)
    ds_read_b64_tr_b16 a[0:1], v3 offset:31232
    ds_read_b64_tr_b16 a[2:3], v3 offset:31488
    v_fma_f32 v220, v220, v9, v10
    v_fma_f32 v60, v60, v9, v10
    v_cvt_pk_bf16_f32 v60, v220, v60
    v_fma_f32 v221, v221, v9, v10
    v_mfma_f32_32x32x16_bf16 a[144:159], a[12:15], v[36:39], a[144:159]
    s_waitcnt lgkmcnt(4)
    ds_read_b64_tr_b16 a[4:5], v3 offset:33280
    ds_read_b64_tr_b16 a[6:7], v3 offset:33536
    buffer_load_dwordx4 v8, s[16:19], s58 offen offset:2688 lds
    v_fma_f32 v61, v61, v9, v10
    v_cvt_pk_bf16_f32 v61, v221, v61
    v_mfma_f32_32x32x16_bf16 a[160:175], a[16:19], v[36:39], a[160:175]
    s_waitcnt lgkmcnt(4)
    ds_read_b64_tr_b16 a[8:9], v3 offset:32256
WPAD12:
    s_cbranch_execz WRET0
    ds_read_b64_tr_b16 a[10:11], v3 offset:32512
    v_fma_f32 v222, v222, v9, v10
    v_fma_f32 v62, v62, v9, v10
    v_cvt_pk_bf16_f32 v62, v222, v62
    v_fma_f32 v223, v223, v9, v10
    v_mfma_f32_32x32x16_bf16 a[176:191], a[20:23], v[36:39], a[176:191]
    s_waitcnt lgkmcnt(4)
    ds_read_b64_tr_b16 a[12:13], v5 offset:11648
    ds_read_b64_tr_b16 a[14:15], v5 offset:11872
    s_add_u32 m0, s45, 27136
    v_fma_f32 v63, v63, v9, v10
    v_cvt_pk_bf16_f32 v63, v223, v63
    v_fma_f32 v224, v224, v9, v10
    v_mfma_f32_32x32x16_bf16 v[128:143], a[0:3], v[40:43], v[128:143]
    s_waitcnt lgkmcnt(4)
    ds_read_b64_tr_b16 a[16:17], v5 offset:11712
    ds_read_b64_tr_b16 a[18:19], v5 offset:11936
    buffer_load_dwordx4 v11, s[8:11], s52 offen lds
    v_fma_f32 v64, v64, v9, v10
    v_cvt_pk_bf16_f32 v64, v224, v64
    v_mfma_f32_32x32x16_bf16 v[144:159], a[4:7], v[40:43], v[144:159]
    s_waitcnt lgkmcnt(4)
    ds_read_b64_tr_b16 a[20:21], v5 offset:11776
    ds_read_b64_tr_b16 a[22:23], v5 offset:12000
    v_fma_f32 v225, v225, v9, v10
    v_fma_f32 v65, v65, v9, v10
    v_cvt_pk_bf16_f32 v65, v225, v65
    v_fma_f32 v226, v226, v9, v10
    v_mfma_f32_32x32x16_bf16 v[160:175], v[40:43], a[8:11], v[160:175]
    s_waitcnt lgkmcnt(4)
    ds_read_b64_tr_b16 a[0:1], v5 offset:11840
    ds_read_b64_tr_b16 a[2:3], v5 offset:12064
    v_fma_f32 v66, v66, v9, v10
    v_cvt_pk_bf16_f32 v66, v226, v66
    v_fma_f32 v227, v227, v9, v10
    v_fma_f32 v67, v67, v9, v10
    v_mfma_f32_32x32x16_bf16 a[128:143], a[12:15], v[40:43], a[128:143]
    s_waitcnt lgkmcnt(4)
    ds_read_b64_tr_b16 a[4:5], v4 offset:14784
    ds_read_b64_tr_b16 a[6:7], v4 offset:15040
    buffer_load_dwordx4 v12, s[8:11], s52 offen offset:1024 lds
    v_cvt_pk_bf16_f32 v67, v227, v67
    v_fma_f32 v228, v228, v9, v10
    v_mfma_f32_32x32x16_bf16 a[144:159], a[16:19], v[40:43], a[144:159]
    s_waitcnt lgkmcnt(4)
    ds_read_b64_tr_b16 a[8:9], v4 offset:16832
    ds_read_b64_tr_b16 a[10:11], v4 offset:17088
    v_fma_f32 v68, v68, v9, v10
    v_cvt_pk_bf16_f32 v68, v228, v68
    v_fma_f32 v229, v229, v9, v10
    v_fma_f32 v69, v69, v9, v10
    v_mfma_f32_32x32x16_bf16 a[160:175], a[20:23], v[40:43], a[160:175]
    s_waitcnt lgkmcnt(4)
    ds_read_b64_tr_b16 a[12:13], v4 offset:15808
    ds_read_b64_tr_b16 a[14:15], v4 offset:16064
    s_add_u32 m0, s45, 28288
    v_cvt_pk_bf16_f32 v69, v229, v69
    v_fma_f32 v230, v230, v9, v10
    v_fma_f32 v70, v70, v9, v10
    v_mfma_f32_32x32x16_bf16 a[176:191], a[0:3], v[40:43], a[176:191]
    s_waitcnt lgkmcnt(4)
    ds_read_b64_tr_b16 a[16:17], v5 offset:12544
    ds_read_b64_tr_b16 a[18:19], v5 offset:12768
    buffer_load_dwordx4 v11, s[8:11], s52 offen offset:896 lds
    v_cvt_pk_bf16_f32 v70, v230, v70
    v_fma_f32 v231, v231, v9, v10
    v_mfma_f32_32x32x16_bf16 v[128:143], a[4:7], v[44:47], v[128:143]
    s_waitcnt lgkmcnt(4)
WPAD13:
    s_cbranch_execz WRET0
    ds_read_b64_tr_b16 a[20:21], v5 offset:12608
    ds_read_b64_tr_b16 a[22:23], v5 offset:12832
    v_fma_f32 v71, v71, v9, v10
    v_cvt_pk_bf16_f32 v71, v231, v71
    v_lshlrev_b32 v248, 16, v72
    v_and_b32 v249, 0xffff0000, v72
    v_mfma_f32_32x32x16_bf16 v[144:159], a[8:11], v[44:47], v[144:159]
    s_waitcnt lgkmcnt(4)
    ds_read_b64_tr_b16 a[0:1], v5 offset:12672
    ds_read_b64_tr_b16 a[2:3], v5 offset:12896
    s_add_u32 m0, s45, 30208
    v_fma_f32 v248, v248, v9, v10
    v_fma_f32 v249, v249, v9, v10
    v_cvt_pk_bf16_f32 v72, v248, v249
    v_mfma_f32_32x32x16_bf16 v[160:175], v[44:47], a[12:15], v[160:175]
    s_waitcnt lgkmcnt(4)
    ds_read_b64_tr_b16 a[4:5], v5 offset:12736
    ds_read_b64_tr_b16 a[6:7], v5 offset:12960
    buffer_load_dwordx4 v7, s[16:19], s59 offen offset:0 lds
    v_lshlrev_b32 v250, 16, v73
    v_and_b32 v251, 0xffff0000, v73
    v_mfma_f32_32x32x16_bf16 a[128:143], a[16:19], v[44:47], a[128:143]
    s_waitcnt lgkmcnt(4)
    s_waitcnt vmcnt(11)
    s_barrier
    ds_read_b64_tr_b16 a[8:9], v2 offset:13568
    ds_read_b64_tr_b16 a[10:11], v2 offset:13824
    v_fma_f32 v250, v250, v9, v10
    v_fma_f32 v251, v251, v9, v10
    v_cvt_pk_bf16_f32 v73, v250, v251
    v_lshlrev_b32 v248, 16, v74
    v_mfma_f32_32x32x16_bf16 a[144:159], a[20:23], v[44:47], a[144:159]
    s_waitcnt lgkmcnt(4)
    ds_read_b64_tr_b16 a[12:13], v2 offset:15616
    ds_read_b64_tr_b16 a[14:15], v2 offset:15872
    v_and_b32 v249, 0xffff0000, v74
    v_fma_f32 v248, v248, v9, v10
    v_fma_f32 v249, v249, v9, v10
    v_cvt_pk_bf16_f32 v74, v248, v249
    v_mfma_f32_32x32x16_bf16 a[160:175], a[0:3], v[44:47], a[160:175]
    s_waitcnt lgkmcnt(4)
    ds_read_b64_tr_b16 a[16:17], v2 offset:14592
    ds_read_b64_tr_b16 a[18:19], v2 offset:14848
    buffer_load_dwordx4 v6, s[16:19], s59 offen offset:896 lds
    v_lshlrev_b32 v250, 16, v75
    v_and_b32 v251, 0xffff0000, v75
    v_mfma_f32_32x32x16_bf16 a[176:191], a[4:7], v[44:47], a[176:191]
    s_waitcnt lgkmcnt(4)
    ds_read_b64_tr_b16 a[20:21], v5 offset:16640
    ds_read_b64_tr_b16 a[22:23], v5 offset:16864
    v_fma_f32 v250, v250, v9, v10
    v_fma_f32 v251, v251, v9, v10
    v_cvt_pk_bf16_f32 v75, v250, v251
    v_lshlrev_b32 v248, 16, v76
    v_mfma_f32_32x32x16_bf16 v[128:143], a[8:11], v[48:51], v[128:143]
    s_waitcnt lgkmcnt(4)
    ds_read_b64_tr_b16 a[0:1], v5 offset:16704
    ds_read_b64_tr_b16 a[2:3], v5 offset:16928
    v_and_b32 v249, 0xffff0000, v76
    v_fma_f32 v248, v248, v9, v10
    v_fma_f32 v249, v249, v9, v10
    v_cvt_pk_bf16_f32 v76, v248, v249
    v_mfma_f32_32x32x16_bf16 v[144:159], a[12:15], v[48:51], v[144:159]
    s_waitcnt lgkmcnt(4)
    ds_read_b64_tr_b16 a[4:5], v5 offset:16768
    ds_read_b64_tr_b16 a[6:7], v5 offset:16992
    buffer_load_dwordx4 v13, s[16:19], s59 offen offset:1792 lds
    v_lshlrev_b32 v250, 16, v77
    v_and_b32 v251, 0xffff0000, v77
    v_mfma_f32_32x32x16_bf16 v[160:175], v[48:51], a[16:19], v[160:175]
    s_waitcnt lgkmcnt(4)
    ds_read_b64_tr_b16 a[8:9], v5 offset:16832
WPAD14:
    s_cbranch_execz WRET0
    ds_read_b64_tr_b16 a[10:11], v5 offset:17056
    v_fma_f32 v250, v250, v9, v10
    v_fma_f32 v251, v251, v9, v10
    v_cvt_pk_bf16_f32 v77, v250, v251
    v_lshlrev_b32 v248, 16, v78
    v_mfma_f32_32x32x16_bf16 a[128:143], a[20:23], v[48:51], a[128:143]
    s_waitcnt lgkmcnt(4)
    ds_read_b64_tr_b16 a[12:13], v2 offset:54464
    ds_read_b64_tr_b16 a[14:15], v2 offset:54720
    v_and_b32 v249, 0xffff0000, v78
    v_fma_f32 v248, v248, v9, v10
    v_fma_f32 v249, v249, v9, v10
    v_cvt_pk_bf16_f32 v78, v248, v249
    v_mfma_f32_32x32x16_bf16 a[144:159], a[0:3], v[48:51], a[144:159]
    s_waitcnt lgkmcnt(4)
    ds_read_b64_tr_b16 a[16:17], v2 offset:56512
    ds_read_b64_tr_b16 a[18:19], v2 offset:56768
    buffer_load_dwordx4 v8, s[16:19], s59 offen offset:2688 lds
    v_lshlrev_b32 v250, 16, v79
    v_and_b32 v251, 0xffff0000, v79
    v_mfma_f32_32x32x16_bf16 a[160:175], a[4:7], v[48:51], a[160:175]
    s_waitcnt lgkmcnt(4)
    ds_read_b64_tr_b16 a[20:21], v2 offset:55488
    ds_read_b64_tr_b16 a[22:23], v2 offset:55744
    v_fma_f32 v250, v250, v9, v10
    v_fma_f32 v251, v251, v9, v10
    v_cvt_pk_bf16_f32 v79, v250, v251
    v_lshlrev_b32 v248, 16, v80
    v_mfma_f32_32x32x16_bf16 a[176:191], a[8:11], v[48:51], a[176:191]
    s_waitcnt lgkmcnt(4)
    ds_read_b64_tr_b16 a[0:1], v5 offset:17536
    ds_read_b64_tr_b16 a[2:3], v5 offset:17760
    s_add_u32 m0, s45, 33920
    v_and_b32 v249, 0xffff0000, v80
    v_fma_f32 v248, v248, v9, v10
    v_fma_f32 v249, v249, v9, v10
    v_mfma_f32_32x32x16_bf16 v[128:143], a[12:15], v[52:55], v[128:143]
    s_waitcnt lgkmcnt(4)
    ds_read_b64_tr_b16 a[4:5], v5 offset:17600
    ds_read_b64_tr_b16 a[6:7], v5 offset:17824
    buffer_load_dwordx4 v11, s[8:11], s53 offen lds
    v_cvt_pk_bf16_f32 v80, v248, v249
    v_lshlrev_b32 v250, 16, v81
    v_mfma_f32_32x32x16_bf16 v[144:159], a[16:19], v[52:55], v[144:159]
    s_waitcnt lgkmcnt(4)
    ds_read_b64_tr_b16 a[8:9], v5 offset:17664
    ds_read_b64_tr_b16 a[10:11], v5 offset:17888
    v_and_b32 v251, 0xffff0000, v81
    v_fma_f32 v250, v250, v9, v10
    v_fma_f32 v251, v251, v9, v10
    v_cvt_pk_bf16_f32 v81, v250, v251
    v_mfma_f32_32x32x16_bf16 v[160:175], v[52:55], a[20:23], v[160:175]
    s_waitcnt lgkmcnt(4)
    ds_read_b64_tr_b16 a[12:13], v5 offset:17728
    ds_read_b64_tr_b16 a[14:15], v5 offset:17952
    v_lshlrev_b32 v248, 16, v82
    v_and_b32 v249, 0xffff0000, v82
    v_fma_f32 v248, v248, v9, v10
    v_fma_f32 v249, v249, v9, v10
    v_mfma_f32_32x32x16_bf16 a[128:143], a[0:3], v[52:55], a[128:143]
    s_waitcnt lgkmcnt(4)
    ds_read_b64_tr_b16 a[16:17], v3 offset:38016
    ds_read_b64_tr_b16 a[18:19], v3 offset:38272
    buffer_load_dwordx4 v12, s[8:11], s53 offen offset:1024 lds
    v_cvt_pk_bf16_f32 v82, v248, v249
    v_lshlrev_b32 v250, 16, v83
    v_mfma_f32_32x32x16_bf16 a[144:159], a[4:7], v[52:55], a[144:159]
    s_waitcnt lgkmcnt(4)
    ds_read_b64_tr_b16 a[20:21], v3 offset:40064
    ds_read_b64_tr_b16 a[22:23], v3 offset:40320
    v_and_b32 v251, 0xffff0000, v83
WPAD15:
    s_cbranch_execz WRET0
    v_fma_f32 v250, v250, v9, v10
    v_fma_f32 v251, v251, v9, v10
    v_cvt_pk_bf16_f32 v83, v250, v251
    v_mfma_f32_32x32x16_bf16 a[160:175], a[8:11], v[52:55], a[160:175]
    s_waitcnt lgkmcnt(4)
    ds_read_b64_tr_b16 a[0:1], v3 offset:39040
    ds_read_b64_tr_b16 a[2:3], v3 offset:39296
    s_add_u32 m0, s45, 35072
    v_lshlrev_b32 v248, 16, v84
    v_and_b32 v249, 0xffff0000, v84
    v_fma_f32 v248, v248, v9, v10
    v_mfma_f32_32x32x16_bf16 a[176:191], a[12:15], v[52:55], a[176:191]
    s_waitcnt lgkmcnt(4)
    ds_read_b64_tr_b16 a[4:5], v5 offset:18432
    ds_read_b64_tr_b16 a[6:7], v5 offset:18656
    buffer_load_dwordx4 v11, s[8:11], s53 offen offset:896 lds
    v_fma_f32 v249, v249, v9, v10
    v_cvt_pk_bf16_f32 v84, v248, v249
    v_mfma_f32_32x32x16_bf16 v[128:143], a[16:19], v[56:59], v[128:143]
    s_waitcnt lgkmcnt(4)
    ds_read_b64_tr_b16 a[8:9], v5 offset:18496
    ds_read_b64_tr_b16 a[10:11], v5 offset:18720
    v_lshlrev_b32 v250, 16, v85
    v_and_b32 v251, 0xffff0000, v85
    v_fma_f32 v250, v250, v9, v10
    v_fma_f32 v251, v251, v9, v10
    v_mfma_f32_32x32x16_bf16 v[144:159], a[20:23], v[56:59], v[144:159]
    s_waitcnt lgkmcnt(4)
    ds_read_b64_tr_b16 a[12:13], v5 offset:18560
    ds_read_b64_tr_b16 a[14:15], v5 offset:18784
    s_add_u32 m0, s45, 36992
    v_cvt_pk_bf16_f32 v85, v250, v251
    v_lshlrev_b32 v248, 16, v86
    v_and_b32 v249, 0xffff0000, v86
    v_mfma_f32_32x32x16_bf16 v[160:175], v[56:59], a[0:3], v[160:175]
    s_waitcnt lgkmcnt(4)
    ds_read_b64_tr_b16 a[16:17], v5 offset:18624
    ds_read_b64_tr_b16 a[18:19], v5 offset:18848
    buffer_load_dwordx4 v7, s[16:19], s60 offen offset:0 lds
    v_fma_f32 v248, v248, v9, v10
    v_fma_f32 v249, v249, v9, v10
    v_mfma_f32_32x32x16_bf16 a[128:143], a[4:7], v[56:59], a[128:143]
    s_waitcnt lgkmcnt(4)
    ds_read_b64_tr_b16 a[20:21], v4 offset:21568
    ds_read_b64_tr_b16 a[22:23], v4 offset:21824
    v_cvt_pk_bf16_f32 v86, v248, v249
    v_lshlrev_b32 v250, 16, v87
    v_and_b32 v251, 0xffff0000, v87
    v_fma_f32 v250, v250, v9, v10
    v_mfma_f32_32x32x16_bf16 a[144:159], a[8:11], v[56:59], a[144:159]
    s_waitcnt lgkmcnt(4)
    ds_read_b64_tr_b16 a[0:1], v4 offset:23616
    ds_read_b64_tr_b16 a[2:3], v4 offset:23872
    v_fma_f32 v251, v251, v9, v10
    v_cvt_pk_bf16_f32 v87, v250, v251
    v_lshlrev_b32 v248, 16, v88
    v_and_b32 v249, 0xffff0000, v88
    v_mfma_f32_32x32x16_bf16 a[160:175], a[12:15], v[56:59], a[160:175]
    s_waitcnt lgkmcnt(4)
    ds_read_b64_tr_b16 a[4:5], v4 offset:22592
    ds_read_b64_tr_b16 a[6:7], v4 offset:22848
    buffer_load_dwordx4 v6, s[16:19], s60 offen offset:896 lds
    v_fma_f32 v248, v248, v9, v10
    v_fma_f32 v249, v249, v9, v10
    v_mfma_f32_32x32x16_bf16 a[176:191], a[16:19], v[56:59], a[176:191]
    s_waitcnt lgkmcnt(4)
    ds_read_b64_tr_b16 a[8:9], v5 offset:19328
    ds_read_b64_tr_b16 a[10:11], v5 offset:19552
    v_cvt_pk_bf16_f32 v88, v248, v249
    v_lshlrev_b32 v250, 16, v89
    v_and_b32 v251, 0xffff0000, v89
WPAD16:
    s_cbranch_execz WRET0
    v_fma_f32 v250, v250, v9, v10
    v_mfma_f32_32x32x16_bf16 v[128:143], a[20:23], v[60:63], v[128:143]
    s_waitcnt lgkmcnt(4)
    ds_read_b64_tr_b16 a[12:13], v5 offset:19392
    ds_read_b64_tr_b16 a[14:15], v5 offset:19616
    v_fma_f32 v251, v251, v9, v10
    v_cvt_pk_bf16_f32 v89, v250, v251
    v_lshlrev_b32 v248, 16, v90
    v_and_b32 v249, 0xffff0000, v90
    v_mfma_f32_32x32x16_bf16 v[144:159], a[0:3], v[60:63], v[144:159]
    s_waitcnt lgkmcnt(4)
    ds_read_b64_tr_b16 a[16:17], v5 offset:19456
    ds_read_b64_tr_b16 a[18:19], v5 offset:19680
    buffer_load_dwordx4 v13, s[16:19], s60 offen offset:1792 lds
    v_fma_f32 v248, v248, v9, v10
    v_fma_f32 v249, v249, v9, v10
    v_mfma_f32_32x32x16_bf16 v[160:175], v[60:63], a[4:7], v[160:175]
    s_waitcnt lgkmcnt(4)
    ds_read_b64_tr_b16 a[20:21], v5 offset:19520
    ds_read_b64_tr_b16 a[22:23], v5 offset:19744
    v_cvt_pk_bf16_f32 v90, v248, v249
    v_lshlrev_b32 v250, 16, v91
    v_and_b32 v251, 0xffff0000, v91
    v_fma_f32 v250, v250, v9, v10
    v_mfma_f32_32x32x16_bf16 a[128:143], a[8:11], v[60:63], a[128:143]
    s_waitcnt lgkmcnt(4)
    s_waitcnt vmcnt(13) lgkmcnt(0)
    s_barrier
    ds_read_b64_tr_b16 a[0:1], v2 offset:20352
    ds_read_b64_tr_b16 a[2:3], v2 offset:20608
    v_fma_f32 v251, v251, v9, v10
    v_cvt_pk_bf16_f32 v91, v250, v251
    v_lshlrev_b32 v248, 16, v92
    v_and_b32 v249, 0xffff0000, v92
    v_mfma_f32_32x32x16_bf16 a[144:159], a[12:15], v[60:63], a[144:159]
    ds_read_b64_tr_b16 a[4:5], v2 offset:22400
    ds_read_b64_tr_b16 a[6:7], v2 offset:22656
    buffer_load_dwordx4 v8, s[16:19], s60 offen offset:2688 lds
    v_fma_f32 v248, v248, v9, v10
    v_fma_f32 v249, v249, v9, v10
    v_mfma_f32_32x32x16_bf16 a[160:175], a[16:19], v[60:63], a[160:175]
    ds_read_b64_tr_b16 a[8:9], v2 offset:21376
    ds_read_b64_tr_b16 a[10:11], v2 offset:21632
    v_cvt_pk_bf16_f32 v92, v248, v249
    v_lshlrev_b32 v250, 16, v93
    v_and_b32 v251, 0xffff0000, v93
    v_fma_f32 v250, v250, v9, v10
    v_mfma_f32_32x32x16_bf16 a[176:191], a[20:23], v[60:63], a[176:191]
    s_waitcnt lgkmcnt(4)
    ds_read_b64_tr_b16 a[12:13], v5 offset:23424
    ds_read_b64_tr_b16 a[14:15], v5 offset:23648
    s_add_u32 m0, s45, 0
    v_fma_f32 v251, v251, v9, v10
    v_cvt_pk_bf16_f32 v93, v250, v251
    v_lshlrev_b32 v248, 16, v94
    v_mfma_f32_32x32x16_bf16 v[128:143], a[0:3], v[64:67], v[128:143]
    s_waitcnt lgkmcnt(4)
    ds_read_b64_tr_b16 a[16:17], v5 offset:23488
    ds_read_b64_tr_b16 a[18:19], v5 offset:23712
    buffer_load_dwordx4 v11, s[8:11], s54 offen lds
    v_and_b32 v249, 0xffff0000, v94
    v_fma_f32 v248, v248, v9, v10
    v_mfma_f32_32x32x16_bf16 v[144:159], a[4:7], v[64:67], v[144:159]
    s_waitcnt lgkmcnt(4)
    ds_read_b64_tr_b16 a[20:21], v5 offset:23552
    ds_read_b64_tr_b16 a[22:23], v5 offset:23776
    v_fma_f32 v249, v249, v9, v10
    v_cvt_pk_bf16_f32 v94, v248, v249
    v_lshlrev_b32 v250, 16, v95
    v_and_b32 v251, 0xffff0000, v95
    v_mfma_f32_32x32x16_bf16 v[160:175], v[64:67], a[8:11], v[160:175]
    s_waitcnt lgkmcnt(4)
WPAD17:
    s_cbranch_execz WRET0
    ds_read_b64_tr_b16 a[0:1], v5 offset:23616
    ds_read_b64_tr_b16 a[2:3], v5 offset:23840
    v_fma_f32 v250, v250, v9, v10
    v_fma_f32 v251, v251, v9, v10
    v_cvt_pk_bf16_f32 v95, v250, v251
    v_lshlrev_b32 v248, 16, v96
    v_mfma_f32_32x32x16_bf16 a[128:143], a[12:15], v[64:67], a[128:143]
    s_waitcnt lgkmcnt(4)
    ds_read_b64_tr_b16 a[4:5], v2 offset:61248
    ds_read_b64_tr_b16 a[6:7], v2 offset:61504
    buffer_load_dwordx4 v12, s[8:11], s54 offen offset:1024 lds
    v_and_b32 v249, 0xffff0000, v96
    v_fma_f32 v248, v248, v9, v10
    v_mfma_f32_32x32x16_bf16 a[144:159], a[16:19], v[64:67], a[144:159]
    s_waitcnt lgkmcnt(4)
    ds_read_b64_tr_b16 a[8:9], v2 offset:63296
    ds_read_b64_tr_b16 a[10:11], v2 offset:63552
    v_fma_f32 v249, v249, v9, v10
    v_cvt_pk_bf16_f32 v96, v248, v249
    v_lshlrev_b32 v250, 16, v97
    v_and_b32 v251, 0xffff0000, v97
    v_mfma_f32_32x32x16_bf16 a[160:175], a[20:23], v[64:67], a[160:175]
    s_waitcnt lgkmcnt(4)
    ds_read_b64_tr_b16 a[12:13], v2 offset:62272
    ds_read_b64_tr_b16 a[14:15], v2 offset:62528
    s_add_u32 m0, s45, 1152
    v_fma_f32 v250, v250, v9, v10
    v_fma_f32 v251, v251, v9, v10
    v_cvt_pk_bf16_f32 v97, v250, v251
    v_mfma_f32_32x32x16_bf16 a[176:191], a[0:3], v[64:67], a[176:191]
    s_waitcnt lgkmcnt(4)
    ds_read_b64_tr_b16 a[16:17], v5 offset:24320
    ds_read_b64_tr_b16 a[18:19], v5 offset:24544
    buffer_load_dwordx4 v11, s[8:11], s54 offen offset:896 lds
    v_lshlrev_b32 v248, 16, v98
    v_and_b32 v249, 0xffff0000, v98
    v_mfma_f32_32x32x16_bf16 v[128:143], a[4:7], v[68:71], v[128:143]
    s_waitcnt lgkmcnt(4)
    ds_read_b64_tr_b16 a[20:21], v5 offset:24384
    ds_read_b64_tr_b16 a[22:23], v5 offset:24608
    v_fma_f32 v248, v248, v9, v10
    v_fma_f32 v249, v249, v9, v10
    v_cvt_pk_bf16_f32 v98, v248, v249
    v_lshlrev_b32 v250, 16, v99
    v_mfma_f32_32x32x16_bf16 v[144:159], a[8:11], v[68:71], v[144:159]
    s_waitcnt lgkmcnt(4)
    ds_read_b64_tr_b16 a[0:1], v5 offset:24448
    ds_read_b64_tr_b16 a[2:3], v5 offset:24672
    s_add_u32 m0, s45, 3072
    v_and_b32 v251, 0xffff0000, v99
    v_fma_f32 v250, v250, v9, v10
    v_fma_f32 v251, v251, v9, v10
    v_mfma_f32_32x32x16_bf16 v[160:175], v[68:71], a[12:15], v[160:175]
    s_waitcnt lgkmcnt(4)
    ds_read_b64_tr_b16 a[4:5], v5 offset:24512
    ds_read_b64_tr_b16 a[6:7], v5 offset:24736
    buffer_load_dwordx4 v7, s[16:19], s61 offen offset:0 lds
    v_cvt_pk_bf16_f32 v99, v250, v251
    v_lshlrev_b32_e64 v248, 16, v100
    v_mfma_f32_32x32x16_bf16 a[128:143], a[16:19], v[68:71], a[128:143]
    s_waitcnt lgkmcnt(4)
    ds_read_b64_tr_b16 a[8:9], v3 offset:44800
    ds_read_b64_tr_b16 a[10:11], v3 offset:45056
    v_and_b32 v249, 0xffff0000, v100
    v_fma_f32 v248, v248, v9, v10
    v_fma_f32 v249, v249, v9, v10
    v_cvt_pk_bf16_f32 v100, v248, v249
    v_mfma_f32_32x32x16_bf16 a[144:159], a[20:23], v[68:71], a[144:159]
    s_waitcnt lgkmcnt(4)
    ds_read_b64_tr_b16 a[12:13], v3 offset:46848
WPAD18:
    s_cbranch_execz WRET0
    ds_read_b64_tr_b16 a[14:15], v3 offset:47104
    v_lshlrev_b32 v250, 16, v101
    v_and_b32 v251, 0xffff0000, v101
    v_fma_f32 v250, v250, v9, v10
    v_fma_f32 v251, v251, v9, v10
    v_mfma_f32_32x32x16_bf16 a[160:175], a[0:3], v[68:71], a[160:175]
    s_waitcnt lgkmcnt(4)
    ds_read_b64_tr_b16 a[16:17], v3 offset:45824
    ds_read_b64_tr_b16 a[18:19], v3 offset:46080
    buffer_load_dwordx4 v6, s[16:19], s61 offen offset:896 lds
    v_cvt_pk_bf16_f32 v101, v250, v251
    v_lshlrev_b32 v248, 16, v102
    v_mfma_f32_32x32x16_bf16 a[176:191], a[4:7], v[68:71], a[176:191]
    s_waitcnt lgkmcnt(4)
    ds_read_b64_tr_b16 a[20:21], v5 offset:25216
    ds_read_b64_tr_b16 a[22:23], v5 offset:25440
    v_and_b32 v249, 0xffff0000, v102
    v_fma_f32 v248, v248, v9, v10
    v_fma_f32 v249, v249, v9, v10
    v_cvt_pk_bf16_f32 v102, v248, v249
    v_mfma_f32_32x32x16_bf16 v[128:143], a[8:11], v[72:75], v[128:143]
    s_waitcnt lgkmcnt(4)
    ds_read_b64_tr_b16 a[0:1], v5 offset:25280
    ds_read_b64_tr_b16 a[2:3], v5 offset:25504
    v_lshlrev_b32 v250, 16, v103
    v_and_b32 v251, 0xffff0000, v103
    v_fma_f32 v250, v250, v9, v10
    v_fma_f32 v251, v251, v9, v10
    v_mfma_f32_32x32x16_bf16 v[144:159], a[12:15], v[72:75], v[144:159]
    s_waitcnt lgkmcnt(4)
    ds_read_b64_tr_b16 a[4:5], v5 offset:25344
    ds_read_b64_tr_b16 a[6:7], v5 offset:25568
    buffer_load_dwordx4 v13, s[16:19], s61 offen offset:1792 lds
    v_cvt_pk_bf16_f32 v103, v250, v251
    v_lshlrev_b32 v248, 16, v104
    v_mfma_f32_32x32x16_bf16 v[160:175], v[72:75], a[16:19], v[160:175]
    s_waitcnt lgkmcnt(4)
    ds_read_b64_tr_b16 a[8:9], v5 offset:25408
    ds_read_b64_tr_b16 a[10:11], v5 offset:25632
    v_and_b32 v249, 0xffff0000, v104
    v_fma_f32 v248, v248, v9, v10
    v_fma_f32 v249, v249, v9, v10
    v_cvt_pk_bf16_f32 v104, v248, v249
    v_mfma_f32_32x32x16_bf16 a[128:143], a[20:23], v[72:75], a[128:143]
    s_waitcnt lgkmcnt(4)
    ds_read_b64_tr_b16 a[12:13], v4 offset:28352
    ds_read_b64_tr_b16 a[14:15], v4 offset:28608
    v_lshlrev_b32 v250, 16, v105
    v_and_b32 v251, 0xffff0000, v105
    v_fma_f32 v250, v250, v9, v10
    v_fma_f32 v251, v251, v9, v10
    v_mfma_f32_32x32x16_bf16 a[144:159], a[0:3], v[72:75], a[144:159]
    s_waitcnt lgkmcnt(4)
    ds_read_b64_tr_b16 a[16:17], v4 offset:30400
    ds_read_b64_tr_b16 a[18:19], v4 offset:30656
    buffer_load_dwordx4 v8, s[16:19], s61 offen offset:2688 lds
    v_cvt_pk_bf16_f32 v105, v250, v251
    v_lshlrev_b32 v248, 16, v106
    v_mfma_f32_32x32x16_bf16 a[160:175], a[4:7], v[72:75], a[160:175]
    s_waitcnt lgkmcnt(4)
    ds_read_b64_tr_b16 a[20:21], v4 offset:29376
    ds_read_b64_tr_b16 a[22:23], v4 offset:29632
    v_and_b32 v249, 0xffff0000, v106
    v_fma_f32 v248, v248, v9, v10
    v_fma_f32 v249, v249, v9, v10
    v_cvt_pk_bf16_f32 v106, v248, v249
    v_mfma_f32_32x32x16_bf16 a[176:191], a[8:11], v[72:75], a[176:191]
    s_waitcnt lgkmcnt(4)
    ds_read_b64_tr_b16 a[0:1], v5 offset:26112
    ds_read_b64_tr_b16 a[2:3], v5 offset:26336
    v_lshlrev_b32_e64 v250, 16, v107
WPAD19:
    s_cbranch_execz WRET0
    v_and_b32 v251, 0xffff0000, v107
    v_fma_f32 v250, v250, v9, v10
    v_fma_f32 v251, v251, v9, v10
    v_mfma_f32_32x32x16_bf16 v[128:143], a[12:15], v[76:79], v[128:143]
    s_waitcnt lgkmcnt(4)
    ds_read_b64_tr_b16 a[4:5], v5 offset:26176
    ds_read_b64_tr_b16 a[6:7], v5 offset:26400
    buffer_load_dword a240, v232, s[36:39], 0 offen
    v_cvt_pk_bf16_f32 v107, v250, v251
    v_lshlrev_b32 v248, 16, v108
    v_and_b32 v249, 0xffff0000, v108
    v_mfma_f32_32x32x16_bf16 v[144:159], a[16:19], v[76:79], v[144:159]
    s_waitcnt lgkmcnt(4)
    ds_read_b64_tr_b16 a[8:9], v5 offset:26240
    ds_read_b64_tr_b16 a[10:11], v5 offset:26464
    v_fma_f32 v248, v248, v9, v10
    v_fma_f32 v249, v249, v9, v10
    v_cvt_pk_bf16_f32 v108, v248, v249
    v_lshlrev_b32 v250, 16, v109
    v_mfma_f32_32x32x16_bf16 v[160:175], v[76:79], a[20:23], v[160:175]
    s_waitcnt lgkmcnt(4)
    ds_read_b64_tr_b16 a[12:13], v5 offset:26304
    ds_read_b64_tr_b16 a[14:15], v5 offset:26528
    v_and_b32 v251, 0xffff0000, v109
    v_fma_f32 v250, v250, v9, v10
    v_fma_f32 v251, v251, v9, v10
    v_cvt_pk_bf16_f32 v109, v250, v251
    v_mfma_f32_32x32x16_bf16 a[128:143], a[0:3], v[76:79], a[128:143]
    s_waitcnt lgkmcnt(4)
    s_waitcnt vmcnt(15)
    s_barrier
    ds_read_b64_tr_b16 a[16:17], v2 offset:27136
    ds_read_b64_tr_b16 a[18:19], v2 offset:27392
    buffer_load_dword a242, v233, s[12:15], 0 offen
    v_lshlrev_b32 v248, 16, v110
    v_and_b32 v249, 0xffff0000, v110
    v_fma_f32 v248, v248, v9, v10
    v_mfma_f32_32x32x16_bf16 a[144:159], a[4:7], v[76:79], a[144:159]
    s_waitcnt lgkmcnt(4)
    ds_read_b64_tr_b16 a[20:21], v2 offset:29184
    ds_read_b64_tr_b16 a[22:23], v2 offset:29440
    v_fma_f32 v249, v249, v9, v10
    v_cvt_pk_bf16_f32 v110, v248, v249
    v_lshlrev_b32 v250, 16, v111
    v_and_b32 v251, 0xffff0000, v111
    v_mfma_f32_32x32x16_bf16 a[160:175], a[8:11], v[76:79], a[160:175]
    s_waitcnt lgkmcnt(4)
    ds_read_b64_tr_b16 a[0:1], v2 offset:28160
    ds_read_b64_tr_b16 a[2:3], v2 offset:28416
    s_add_u32 m0, s45, 7424
    v_fma_f32 v250, v250, v9, v10
    v_fma_f32 v251, v251, v9, v10
    v_cvt_pk_bf16_f32 v111, v250, v251
    v_mfma_f32_32x32x16_bf16 a[176:191], a[12:15], v[76:79], a[176:191]
    s_waitcnt lgkmcnt(4)
    ds_read_b64_tr_b16 a[4:5], v5 offset:30208
    ds_read_b64_tr_b16 a[6:7], v5 offset:30432
    buffer_load_dwordx4 v7, s[20:23], s55 offen offset:0 lds
    v_lshlrev_b32 v248, 16, v112
    v_and_b32 v249, 0xffff0000, v112
    v_mfma_f32_32x32x16_bf16 v[128:143], a[16:19], v[80:83], v[128:143]
    s_waitcnt lgkmcnt(4)
    ds_read_b64_tr_b16 a[8:9], v5 offset:30272
    ds_read_b64_tr_b16 a[10:11], v5 offset:30496
    v_fma_f32 v248, v248, v9, v10
    v_fma_f32 v249, v249, v9, v10
    v_cvt_pk_bf16_f32 v112, v248, v249
    v_lshlrev_b32 v250, 16, v113
    v_mfma_f32_32x32x16_bf16 v[144:159], a[20:23], v[80:83], v[144:159]
    s_waitcnt lgkmcnt(4)
    ds_read_b64_tr_b16 a[12:13], v5 offset:30336
    ds_read_b64_tr_b16 a[14:15], v5 offset:30560
WPAD20:
    s_cbranch_execz WRET0
    v_and_b32 v251, 0xffff0000, v113
    v_fma_f32 v250, v250, v9, v10
    v_fma_f32 v251, v251, v9, v10
    v_cvt_pk_bf16_f32 v113, v250, v251
    v_mfma_f32_32x32x16_bf16 v[160:175], v[80:83], a[0:3], v[160:175]
    s_waitcnt lgkmcnt(4)
    ds_read_b64_tr_b16 a[16:17], v5 offset:30400
    ds_read_b64_tr_b16 a[18:19], v5 offset:30624
    buffer_load_dwordx4 v6, s[20:23], s55 offen offset:896 lds
    v_lshlrev_b32 v248, 16, v114
    v_and_b32 v249, 0xffff0000, v114
    v_mfma_f32_32x32x16_bf16 a[128:143], a[4:7], v[80:83], a[128:143]
    s_waitcnt lgkmcnt(4)
    ds_read_b64_tr_b16 a[20:21], v3 offset:10688
    ds_read_b64_tr_b16 a[22:23], v3 offset:10944
    v_fma_f32 v248, v248, v9, v10
    v_fma_f32 v249, v249, v9, v10
    v_cvt_pk_bf16_f32 v114, v248, v249
    v_lshlrev_b32 v250, 16, v115
    v_mfma_f32_32x32x16_bf16 a[144:159], a[8:11], v[80:83], a[144:159]
    s_waitcnt lgkmcnt(4)
    ds_read_b64_tr_b16 a[0:1], v3 offset:12736
    ds_read_b64_tr_b16 a[2:3], v3 offset:12992
    v_and_b32 v251, 0xffff0000, v115
    v_fma_f32 v250, v250, v9, v10
    v_fma_f32 v251, v251, v9, v10
    v_cvt_pk_bf16_f32 v115, v250, v251
    v_mfma_f32_32x32x16_bf16 a[160:175], a[12:15], v[80:83], a[160:175]
    s_waitcnt lgkmcnt(4)
    ds_read_b64_tr_b16 a[4:5], v3 offset:11712
    ds_read_b64_tr_b16 a[6:7], v3 offset:11968
    buffer_load_dwordx4 v13, s[20:23], s55 offen offset:1792 lds
    v_lshlrev_b32 v248, 16, v116
    v_and_b32 v249, 0xffff0000, v116
    v_mfma_f32_32x32x16_bf16 a[176:191], a[16:19], v[80:83], a[176:191]
    s_waitcnt lgkmcnt(4)
    ds_read_b64_tr_b16 a[8:9], v5 offset:31104
    ds_read_b64_tr_b16 a[10:11], v5 offset:31328
    v_fma_f32 v248, v248, v9, v10
    v_fma_f32 v249, v249, v9, v10
    v_cvt_pk_bf16_f32 v116, v248, v249
    v_lshlrev_b32 v250, 16, v117
    v_mfma_f32_32x32x16_bf16 v[128:143], a[20:23], v[84:87], v[128:143]
    s_waitcnt lgkmcnt(4)
    ds_read_b64_tr_b16 a[12:13], v5 offset:31168
    ds_read_b64_tr_b16 a[14:15], v5 offset:31392
    v_and_b32 v251, 0xffff0000, v117
    v_fma_f32 v250, v250, v9, v10
    v_fma_f32 v251, v251, v9, v10
    v_cvt_pk_bf16_f32 v117, v250, v251
    v_mfma_f32_32x32x16_bf16 v[144:159], a[0:3], v[84:87], v[144:159]
    s_waitcnt lgkmcnt(4)
    ds_read_b64_tr_b16 a[16:17], v5 offset:31232
    ds_read_b64_tr_b16 a[18:19], v5 offset:31456
    buffer_load_dwordx4 v8, s[20:23], s55 offen offset:2688 lds
    v_lshlrev_b32 v248, 16, v118
    v_and_b32 v249, 0xffff0000, v118
    v_mfma_f32_32x32x16_bf16 v[160:175], v[84:87], a[4:7], v[160:175]
    s_waitcnt lgkmcnt(4)
    ds_read_b64_tr_b16 a[20:21], v5 offset:31296
    ds_read_b64_tr_b16 a[22:23], v5 offset:31520
    v_fma_f32 v248, v248, v9, v10
    v_fma_f32 v249, v249, v9, v10
    v_cvt_pk_bf16_f32 v118, v248, v249
    v_lshlrev_b32 v250, 16, v119
    v_mfma_f32_32x32x16_bf16 a[128:143], a[8:11], v[84:87], a[128:143]
    s_waitcnt lgkmcnt(4)
    ds_read_b64_tr_b16 a[0:1], v3 offset:51584
    ds_read_b64_tr_b16 a[2:3], v3 offset:51840
    s_add_u32 m0, s45, 11136
    v_and_b32 v251, 0xffff0000, v119
WPAD21:
    s_cbranch_execz WRET0
    v_fma_f32 v250, v250, v9, v10
    v_fma_f32 v251, v251, v9, v10
    v_mfma_f32_32x32x16_bf16 a[144:159], a[12:15], v[84:87], a[144:159]
    s_waitcnt lgkmcnt(4)
    ds_read_b64_tr_b16 a[4:5], v3 offset:53632
    ds_read_b64_tr_b16 a[6:7], v3 offset:53888
    buffer_load_dwordx4 v7, s[20:23], s56 offen offset:0 lds
    v_cvt_pk_bf16_f32 v119, v250, v251
    v_lshlrev_b32 v248, 16, v120
    v_mfma_f32_32x32x16_bf16 a[160:175], a[16:19], v[84:87], a[160:175]
    s_waitcnt lgkmcnt(4)
    ds_read_b64_tr_b16 a[8:9], v3 offset:52608
    ds_read_b64_tr_b16 a[10:11], v3 offset:52864
    v_and_b32 v249, 0xffff0000, v120
    v_fma_f32 v248, v248, v9, v10
    v_fma_f32 v249, v249, v9, v10
    v_cvt_pk_bf16_f32 v120, v248, v249
    v_mfma_f32_32x32x16_bf16 a[176:191], a[20:23], v[84:87], a[176:191]
    s_waitcnt lgkmcnt(4)
    ds_read_b64_tr_b16 a[12:13], v5 offset:32000
    ds_read_b64_tr_b16 a[14:15], v5 offset:32224
    v_lshlrev_b32 v250, 16, v121
    v_and_b32 v251, 0xffff0000, v121
    v_fma_f32 v250, v250, v9, v10
    v_fma_f32 v251, v251, v9, v10
    v_mfma_f32_32x32x16_bf16 v[128:143], a[0:3], v[88:91], v[128:143]
    s_waitcnt lgkmcnt(4)
    ds_read_b64_tr_b16 a[16:17], v5 offset:32064
    ds_read_b64_tr_b16 a[18:19], v5 offset:32288
    buffer_load_dwordx4 v6, s[20:23], s56 offen offset:896 lds
    v_cvt_pk_bf16_f32 v121, v250, v251
    v_lshlrev_b32 v248, 16, v122
    v_mfma_f32_32x32x16_bf16 v[144:159], a[4:7], v[88:91], v[144:159]
    s_waitcnt lgkmcnt(4)
    ds_read_b64_tr_b16 a[20:21], v5 offset:32128
    ds_read_b64_tr_b16 a[22:23], v5 offset:32352
    v_and_b32 v249, 0xffff0000, v122
    v_fma_f32 v248, v248, v9, v10
    v_fma_f32 v249, v249, v9, v10
    v_cvt_pk_bf16_f32 v122, v248, v249
    v_mfma_f32_32x32x16_bf16 v[160:175], v[88:91], a[8:11], v[160:175]
    s_waitcnt lgkmcnt(4)
    ds_read_b64_tr_b16 a[0:1], v5 offset:32192
    ds_read_b64_tr_b16 a[2:3], v5 offset:32416
    v_lshlrev_b32 v250, 16, v123
    v_and_b32 v251, 0xffff0000, v123
    v_fma_f32 v250, v250, v9, v10
    v_fma_f32 v251, v251, v9, v10
    v_mfma_f32_32x32x16_bf16 a[128:143], a[12:15], v[88:91], a[128:143]
    s_waitcnt lgkmcnt(4)
    ds_read_b64_tr_b16 a[4:5], v4 offset:35136
    ds_read_b64_tr_b16 a[6:7], v4 offset:35392
    buffer_load_dwordx4 v13, s[20:23], s56 offen offset:1792 lds
    v_cvt_pk_bf16_f32 v123, v250, v251
    v_lshlrev_b32 v248, 16, v124
    v_mfma_f32_32x32x16_bf16 a[144:159], a[16:19], v[88:91], a[144:159]
    s_waitcnt lgkmcnt(4)
    ds_read_b64_tr_b16 a[8:9], v4 offset:37184
    ds_read_b64_tr_b16 a[10:11], v4 offset:37440
    v_and_b32 v249, 0xffff0000, v124
    v_fma_f32 v248, v248, v9, v10
    v_fma_f32 v249, v249, v9, v10
    v_cvt_pk_bf16_f32 v124, v248, v249
    v_mfma_f32_32x32x16_bf16 a[160:175], a[20:23], v[88:91], a[160:175]
    s_waitcnt lgkmcnt(4)
    ds_read_b64_tr_b16 a[12:13], v4 offset:36160
    ds_read_b64_tr_b16 a[14:15], v4 offset:36416
    v_lshlrev_b32 v250, 16, v125
    v_and_b32 v251, 0xffff0000, v125
    v_fma_f32 v250, v250, v9, v10
    v_fma_f32 v251, v251, v9, v10
WPAD22:
    s_cbranch_execz WRET0
    v_mfma_f32_32x32x16_bf16 a[176:191], a[0:3], v[88:91], a[176:191]
    s_waitcnt lgkmcnt(4)
    ds_read_b64_tr_b16 a[16:17], v5 offset:32896
    ds_read_b64_tr_b16 a[18:19], v5 offset:33120
    buffer_load_dwordx4 v8, s[20:23], s56 offen offset:2688 lds
    v_cvt_pk_bf16_f32 v125, v250, v251
    v_lshlrev_b32 v248, 16, v126
    v_mfma_f32_32x32x16_bf16 v[128:143], a[4:7], v[92:95], v[128:143]
    s_waitcnt lgkmcnt(4)
    ds_read_b64_tr_b16 a[20:21], v5 offset:32960
    ds_read_b64_tr_b16 a[22:23], v5 offset:33184
    v_and_b32 v249, 0xffff0000, v126
    v_fma_f32 v248, v248, v9, v10
    v_fma_f32 v249, v249, v9, v10
    v_cvt_pk_bf16_f32 v126, v248, v249
    v_mfma_f32_32x32x16_bf16 v[144:159], a[8:11], v[92:95], v[144:159]
    s_waitcnt lgkmcnt(4)
    ds_read_b64_tr_b16 a[0:1], v5 offset:33024
    ds_read_b64_tr_b16 a[2:3], v5 offset:33248
    s_add_u32 m0, s45, 14848
    v_lshlrev_b32 v250, 16, v127
    v_and_b32 v251, 0xffff0000, v127
    v_fma_f32 v250, v250, v9, v10
    v_mfma_f32_32x32x16_bf16 v[160:175], v[92:95], a[12:15], v[160:175]
    s_waitcnt lgkmcnt(4)
    ds_read_b64_tr_b16 a[4:5], v5 offset:33088
    ds_read_b64_tr_b16 a[6:7], v5 offset:33312
    buffer_load_dwordx4 v7, s[20:23], s57 offen offset:0 lds
    v_fma_f32 v251, v251, v9, v10
    v_cvt_pk_bf16_f32 v127, v250, v251
    v_mfma_f32_32x32x16_bf16 a[128:143], a[16:19], v[92:95], a[128:143]
    s_waitcnt lgkmcnt(4)
    s_waitcnt vmcnt(18)
    s_barrier
    ds_read_b64_tr_b16 a[8:9], v2 offset:33920
    ds_read_b64_tr_b16 a[10:11], v2 offset:34176
    v_min_u32 v11, 1, v1
    v_lshlrev_b32 v11, 31, v11
    v_mov_b32 v12, s46
    v_accvgpr_write_b32 a244, -1
    v_mfma_f32_32x32x16_bf16 a[144:159], a[20:23], v[92:95], a[144:159]
    s_waitcnt lgkmcnt(4)
    ds_read_b64_tr_b16 a[12:13], v2 offset:35968
    ds_read_b64_tr_b16 a[14:15], v2 offset:36224
    v_accvgpr_write_b32 a245, -1
    v_accvgpr_write_b32 a246, -1
    v_accvgpr_write_b32 a247, -1
    v_mfma_f32_32x32x16_bf16 a[160:175], a[0:3], v[92:95], a[160:175]
    s_waitcnt lgkmcnt(4)
    ds_read_b64_tr_b16 a[16:17], v2 offset:34944
    ds_read_b64_tr_b16 a[18:19], v2 offset:35200
    buffer_load_dwordx4 v6, s[20:23], s57 offen offset:896 lds
    v_mfma_f32_32x32x16_bf16 a[176:191], a[4:7], v[92:95], a[176:191]
    s_waitcnt lgkmcnt(4)
    ds_read_b64_tr_b16 a[20:21], v5 offset:36992
    ds_read_b64_tr_b16 a[22:23], v5 offset:37216
    v_mfma_f32_32x32x16_bf16 v[128:143], a[8:11], v[96:99], v[128:143]
    s_waitcnt lgkmcnt(4)
    ds_read_b64_tr_b16 a[0:1], v5 offset:37056
    ds_read_b64_tr_b16 a[2:3], v5 offset:37280
    v_mfma_f32_32x32x16_bf16 v[144:159], a[12:15], v[96:99], v[144:159]
    s_waitcnt lgkmcnt(4)
    ds_read_b64_tr_b16 a[4:5], v5 offset:37120
    ds_read_b64_tr_b16 a[6:7], v5 offset:37344
    buffer_load_dwordx4 v13, s[20:23], s57 offen offset:1792 lds
    v_mfma_f32_32x32x16_bf16 v[160:175], v[96:99], a[16:19], v[160:175]
    s_waitcnt lgkmcnt(4)
    ds_read_b64_tr_b16 a[8:9], v5 offset:37184
    ds_read_b64_tr_b16 a[10:11], v5 offset:37408
    v_mfma_f32_32x32x16_bf16 a[128:143], a[20:23], v[96:99], a[128:143]
    s_waitcnt lgkmcnt(4)
    ds_read_b64_tr_b16 a[12:13], v3 offset:17472
    ds_read_b64_tr_b16 a[14:15], v3 offset:17728
WPAD23:
    s_cbranch_execz WRET0
    v_mfma_f32_32x32x16_bf16 a[144:159], a[0:3], v[96:99], a[144:159]
    s_waitcnt lgkmcnt(4)
    ds_read_b64_tr_b16 a[16:17], v3 offset:19520
    ds_read_b64_tr_b16 a[18:19], v3 offset:19776
    buffer_load_dwordx4 v8, s[20:23], s57 offen offset:2688 lds
    v_mfma_f32_32x32x16_bf16 a[160:175], a[4:7], v[96:99], a[160:175]
    s_waitcnt lgkmcnt(4)
    ds_read_b64_tr_b16 a[20:21], v3 offset:18496
    ds_read_b64_tr_b16 a[22:23], v3 offset:18752
    v_mfma_f32_32x32x16_bf16 a[176:191], a[8:11], v[96:99], a[176:191]
    s_waitcnt lgkmcnt(4)
    ds_read_b64_tr_b16 a[0:1], v5 offset:37888
    ds_read_b64_tr_b16 a[2:3], v5 offset:38112
    v_mfma_f32_32x32x16_bf16 v[128:143], a[12:15], v[100:103], v[128:143]
    s_waitcnt lgkmcnt(4)
    ds_read_b64_tr_b16 a[4:5], v5 offset:37952
    ds_read_b64_tr_b16 a[6:7], v5 offset:38176
    v_mfma_f32_32x32x16_bf16 v[144:159], a[16:19], v[100:103], v[144:159]
    s_waitcnt lgkmcnt(4)
    ds_read_b64_tr_b16 a[8:9], v5 offset:38016
    ds_read_b64_tr_b16 a[10:11], v5 offset:38240
    v_mfma_f32_32x32x16_bf16 v[160:175], v[100:103], a[20:23], v[160:175]
    s_waitcnt lgkmcnt(4)
    ds_read_b64_tr_b16 a[12:13], v5 offset:38080
    ds_read_b64_tr_b16 a[14:15], v5 offset:38304
    v_mfma_f32_32x32x16_bf16 a[128:143], a[0:3], v[100:103], a[128:143]
    s_waitcnt lgkmcnt(4)
    ds_read_b64_tr_b16 a[16:17], v3 offset:58368
    ds_read_b64_tr_b16 a[18:19], v3 offset:58624
    v_mfma_f32_32x32x16_bf16 a[144:159], a[4:7], v[100:103], a[144:159]
    s_waitcnt lgkmcnt(4)
    ds_read_b64_tr_b16 a[20:21], v3 offset:60416
    ds_read_b64_tr_b16 a[22:23], v3 offset:60672
    v_mfma_f32_32x32x16_bf16 a[160:175], a[8:11], v[100:103], a[160:175]
    s_waitcnt lgkmcnt(4)
    ds_read_b64_tr_b16 a[0:1], v3 offset:59392
    ds_read_b64_tr_b16 a[2:3], v3 offset:59648
    v_mfma_f32_32x32x16_bf16 a[176:191], a[12:15], v[100:103], a[176:191]
    s_waitcnt lgkmcnt(4)
    ds_read_b64_tr_b16 a[4:5], v5 offset:38784
    ds_read_b64_tr_b16 a[6:7], v5 offset:39008
    v_mfma_f32_32x32x16_bf16 v[128:143], a[16:19], v[104:107], v[128:143]
    s_waitcnt lgkmcnt(4)
    ds_read_b64_tr_b16 a[8:9], v5 offset:38848
    ds_read_b64_tr_b16 a[10:11], v5 offset:39072
    v_mfma_f32_32x32x16_bf16 v[144:159], a[20:23], v[104:107], v[144:159]
    s_waitcnt lgkmcnt(4)
    ds_read_b64_tr_b16 a[12:13], v5 offset:38912
    ds_read_b64_tr_b16 a[14:15], v5 offset:39136
    v_mfma_f32_32x32x16_bf16 v[160:175], v[104:107], a[0:3], v[160:175]
    s_waitcnt lgkmcnt(4)
    ds_read_b64_tr_b16 a[16:17], v5 offset:38976
    ds_read_b64_tr_b16 a[18:19], v5 offset:39200
    v_mfma_f32_32x32x16_bf16 a[128:143], a[4:7], v[104:107], a[128:143]
    s_waitcnt lgkmcnt(4)
    ds_read_b64_tr_b16 a[20:21], v4 offset:41920
    ds_read_b64_tr_b16 a[22:23], v4 offset:42176
    v_mfma_f32_32x32x16_bf16 a[144:159], a[8:11], v[104:107], a[144:159]
    s_waitcnt lgkmcnt(4)
    ds_read_b64_tr_b16 a[0:1], v4 offset:43968
    ds_read_b64_tr_b16 a[2:3], v4 offset:44224
    v_mfma_f32_32x32x16_bf16 a[160:175], a[12:15], v[104:107], a[160:175]
    s_waitcnt lgkmcnt(4)
    ds_read_b64_tr_b16 a[4:5], v4 offset:42944
    ds_read_b64_tr_b16 a[6:7], v4 offset:43200
    v_mfma_f32_32x32x16_bf16 a[176:191], a[16:19], v[104:107], a[176:191]
    s_waitcnt lgkmcnt(4)
    ds_read_b64_tr_b16 a[8:9], v5 offset:39680
    ds_read_b64_tr_b16 a[10:11], v5 offset:39904
    v_mfma_f32_32x32x16_bf16 v[128:143], a[20:23], v[108:111], v[128:143]
    s_waitcnt lgkmcnt(4)
    ds_read_b64_tr_b16 a[12:13], v5 offset:39744
    s_nop 0
WPAD24:
    s_cbranch_execz WRET0
    ds_read_b64_tr_b16 a[14:15], v5 offset:39968
    v_mfma_f32_32x32x16_bf16 v[144:159], a[0:3], v[108:111], v[144:159]
    s_waitcnt lgkmcnt(4)
    ds_read_b64_tr_b16 a[16:17], v5 offset:39808
    ds_read_b64_tr_b16 a[18:19], v5 offset:40032
    v_mfma_f32_32x32x16_bf16 v[160:175], v[108:111], a[4:7], v[160:175]
    s_waitcnt lgkmcnt(4)
    ds_read_b64_tr_b16 a[20:21], v5 offset:39872
    ds_read_b64_tr_b16 a[22:23], v5 offset:40096
    v_mfma_f32_32x32x16_bf16 a[128:143], a[8:11], v[108:111], a[128:143]
    s_waitcnt lgkmcnt(4)
    s_waitcnt vmcnt(14)
    s_barrier
    ds_read_b64_tr_b16 a[0:1], v2 offset:2048
    ds_read_b64_tr_b16 a[2:3], v2 offset:2304
    v_mfma_f32_32x32x16_bf16 a[144:159], a[12:15], v[108:111], a[144:159]
    s_waitcnt lgkmcnt(4)
    ds_read_b64_tr_b16 a[4:5], v2 offset:42944
    ds_read_b64_tr_b16 a[6:7], v2 offset:43200
    v_mfma_f32_32x32x16_bf16 a[160:175], a[16:19], v[108:111], a[160:175]
    s_waitcnt lgkmcnt(4)
    ds_read_b64_tr_b16 a[8:9], v3 offset:26496
    ds_read_b64_tr_b16 a[10:11], v3 offset:26752
    v_mfma_f32_32x32x16_bf16 a[176:191], a[20:23], v[108:111], a[176:191]
    s_waitcnt lgkmcnt(4)
    ds_read_b64_tr_b16 a[12:13], v4 offset:10048
    ds_read_b64_tr_b16 a[14:15], v4 offset:10304
    v_mfma_f32_32x32x16_bf16 v[144:159], a[0:3], v[112:115], v[144:159]
    s_waitcnt lgkmcnt(4)
    ds_read_b64_tr_b16 a[16:17], v2 offset:1024
    ds_read_b64_tr_b16 a[18:19], v2 offset:1280
    v_mfma_f32_32x32x16_bf16 v[144:159], a[4:7], v[116:119], v[144:159]
    s_waitcnt lgkmcnt(4)
    ds_read_b64_tr_b16 a[20:21], v2 offset:41920
    ds_read_b64_tr_b16 a[22:23], v2 offset:42176
    v_mfma_f32_32x32x16_bf16 v[144:159], a[8:11], v[120:123], v[144:159]
    s_waitcnt lgkmcnt(4)
    ds_read_b64_tr_b16 a[0:1], v3 offset:25472
    ds_read_b64_tr_b16 a[2:3], v3 offset:25728
    v_mfma_f32_32x32x16_bf16 v[144:159], a[12:15], v[124:127], v[144:159]
    s_waitcnt lgkmcnt(4)
    ds_read_b64_tr_b16 a[4:5], v4 offset:9024
    ds_read_b64_tr_b16 a[6:7], v4 offset:9280
    buffer_store_dwordx4 a[244:247], v1, s[32:35], s79 offen offset:0 sc1
    v_mfma_f32_32x32x16_bf16 v[160:175], v[112:115], a[16:19], v[160:175]
    s_waitcnt lgkmcnt(4)
    ds_read_b64_tr_b16 a[8:9], v2 offset:0
    ds_read_b64_tr_b16 a[10:11], v2 offset:256
    buffer_store_dwordx4 a[244:247], v1, s[32:35], s79 offen offset:1024 sc1
    v_mfma_f32_32x32x16_bf16 v[160:175], v[116:119], a[20:23], v[160:175]
    s_waitcnt lgkmcnt(4)
    ds_read_b64_tr_b16 a[12:13], v2 offset:40896
    ds_read_b64_tr_b16 a[14:15], v2 offset:41152
    v_cvt_pk_bf16_f32 v240, v144, v145
    v_cvt_pk_bf16_f32 v241, v146, v147
    v_cvt_pk_bf16_f32 v242, v148, v149
    v_cvt_pk_bf16_f32 v243, v150, v151
    v_mfma_f32_32x32x16_bf16 v[160:175], v[120:123], a[0:3], v[160:175]
    s_waitcnt lgkmcnt(4)
    ds_read_b64_tr_b16 a[16:17], v3 offset:24448
    ds_read_b64_tr_b16 a[18:19], v3 offset:24704
    buffer_store_dwordx4 v[240:243], v1, s[32:35], s66 offen offset:0 sc1
    v_cvt_pk_bf16_f32 v244, v152, v153
    v_cvt_pk_bf16_f32 v245, v154, v155
    v_cvt_pk_bf16_f32 v246, v156, v157
    v_mfma_f32_32x32x16_bf16 v[160:175], v[124:127], a[4:7], v[160:175]
    s_waitcnt lgkmcnt(4)
    ds_read_b64_tr_b16 a[20:21], v4 offset:8000
    ds_read_b64_tr_b16 a[22:23], v4 offset:8256
    s_add_u32 m0, s45, 18560
    v_cvt_pk_bf16_f32 v247, v158, v159
    s_nop 0
WPAD25:
    s_cbranch_execz WRET0
    v_cndmask_b32 v246, v246, v15, s[94:95]
    v_cndmask_b32 v247, v247, 0, s[94:95]
    v_mfma_f32_32x32x16_bf16 v[128:143], a[8:11], v[112:115], v[128:143]
    s_waitcnt lgkmcnt(4)
    ds_read_b64_tr_b16 a[0:1], v5 offset:3072
    ds_read_b64_tr_b16 a[2:3], v5 offset:3296
    buffer_store_dwordx4 v[244:247], v1, s[32:35], s66 offen offset:1024 sc1
    v_mfma_f32_32x32x16_bf16 v[128:143], a[12:15], v[116:119], v[128:143]
    s_waitcnt lgkmcnt(4)
    ds_read_b64_tr_b16 a[4:5], v5 offset:3968
    ds_read_b64_tr_b16 a[6:7], v5 offset:4192
    v_cvt_pk_bf16_f32 v160, v160, v161
    v_cndmask_b32 v160, v160, v15, s[96:97]
    v_cvt_pk_bf16_f32 v161, v162, v163
    v_cndmask_b32 v161, v161, v15, s[96:97]
    v_mfma_f32_32x32x16_bf16 v[128:143], a[16:19], v[120:123], v[128:143]
    s_waitcnt lgkmcnt(4)
    ds_read_b64_tr_b16 a[8:9], v5 offset:4864
    ds_read_b64_tr_b16 a[10:11], v5 offset:5088
    v_cvt_pk_bf16_f32 v162, v164, v165
    v_cndmask_b32 v162, v162, v15, s[96:97]
    v_cvt_pk_bf16_f32 v163, v166, v167
    v_cndmask_b32 v163, v163, v15, s[96:97]
    v_mfma_f32_32x32x16_bf16 v[128:143], a[20:23], v[124:127], v[128:143]
    s_waitcnt lgkmcnt(4)
    ds_read_b64_tr_b16 a[12:13], v5 offset:5760
    ds_read_b64_tr_b16 a[14:15], v5 offset:5984
    buffer_store_dwordx4 v[160:163], v1, s[32:35], s66 offen offset:2048 sc1
    v_cvt_pk_bf16_f32 v164, v168, v169
    v_cndmask_b32 v164, v164, v15, s[96:97]
    v_cvt_pk_bf16_f32 v165, v170, v171
    v_mfma_f32_32x32x16_bf16 a[128:143], a[0:3], v[112:115], a[128:143]
    s_waitcnt lgkmcnt(4)
    ds_read_b64_tr_b16 a[16:17], v5 offset:3136
    ds_read_b64_tr_b16 a[18:19], v5 offset:3360
    v_cndmask_b32 v165, v165, v15, s[96:97]
    v_cvt_pk_bf16_f32 v166, v172, v173
    v_cndmask_b32 v166, v166, v15, s[96:97]
    v_cvt_pk_bf16_f32 v167, v174, v175
    v_mfma_f32_32x32x16_bf16 a[128:143], a[4:7], v[116:119], a[128:143]
    s_waitcnt lgkmcnt(4)
    ds_read_b64_tr_b16 a[20:21], v5 offset:4032
    ds_read_b64_tr_b16 a[22:23], v5 offset:4256
    v_cndmask_b32 v167, v167, v15, s[96:97]
    v_mul_f32 v128, s90, v128
    v_mul_f32 v129, s90, v129
    v_cvt_pk_bf16_f32 v128, v128, v129
    v_mfma_f32_32x32x16_bf16 a[128:143], a[8:11], v[120:123], a[128:143]
    s_waitcnt lgkmcnt(4)
    ds_read_b64_tr_b16 a[0:1], v5 offset:4928
    ds_read_b64_tr_b16 a[2:3], v5 offset:5152
    buffer_store_dwordx4 v[164:167], v1, s[32:35], s66 offen offset:3072 sc1
    v_mul_f32 v130, s90, v130
    v_mul_f32 v131, s90, v131
    v_cvt_pk_bf16_f32 v129, v130, v131
    v_mfma_f32_32x32x16_bf16 a[128:143], a[12:15], v[124:127], a[128:143]
    s_waitcnt lgkmcnt(4)
    ds_read_b64_tr_b16 a[4:5], v5 offset:5824
    ds_read_b64_tr_b16 a[6:7], v5 offset:6048
    buffer_load_dwordx4 v7, s[20:23], s58 offen offset:0 lds
    v_mul_f32 v132, s90, v132
    v_mul_f32 v133, s90, v133
    v_mfma_f32_32x32x16_bf16 a[144:159], a[16:19], v[112:115], a[144:159]
    s_waitcnt lgkmcnt(4)
    ds_read_b64_tr_b16 a[8:9], v5 offset:3200
    ds_read_b64_tr_b16 a[10:11], v5 offset:3424
    buffer_load_dwordx4 v6, s[20:23], s58 offen offset:896 lds
    v_cvt_pk_bf16_f32 v130, v132, v133
    v_mul_f32 v134, s90, v134
    v_mfma_f32_32x32x16_bf16 a[144:159], a[20:23], v[116:119], a[144:159]
    s_waitcnt lgkmcnt(4)
    ds_read_b64_tr_b16 a[12:13], v5 offset:4096
WPAD26:
    s_cbranch_execz WRET0
    ds_read_b64_tr_b16 a[14:15], v5 offset:4320
    buffer_load_dwordx4 v13, s[20:23], s58 offen offset:1792 lds
    v_mul_f32 v135, s90, v135
    v_cvt_pk_bf16_f32 v131, v134, v135
    v_mfma_f32_32x32x16_bf16 a[144:159], a[0:3], v[120:123], a[144:159]
    s_waitcnt lgkmcnt(4)
    ds_read_b64_tr_b16 a[16:17], v5 offset:4992
    ds_read_b64_tr_b16 a[18:19], v5 offset:5216
    buffer_load_dwordx4 v8, s[20:23], s58 offen offset:2688 lds
    s_add_u32 m0, s45, 22272
    v_mul_f32 v136, s90, v136
    v_mfma_f32_32x32x16_bf16 a[144:159], a[4:7], v[124:127], a[144:159]
    s_waitcnt lgkmcnt(4)
    ds_read_b64_tr_b16 a[20:21], v5 offset:5888
    ds_read_b64_tr_b16 a[22:23], v5 offset:6112
    buffer_load_dwordx4 v7, s[20:23], s59 offen offset:0 lds
    v_mul_f32 v137, s90, v137
    v_cvt_pk_bf16_f32 v132, v136, v137
    v_mfma_f32_32x32x16_bf16 a[160:175], a[8:11], v[112:115], a[160:175]
    s_waitcnt lgkmcnt(4)
    ds_read_b64_tr_b16 a[0:1], v5 offset:3264
    ds_read_b64_tr_b16 a[2:3], v5 offset:3488
    buffer_load_dwordx4 v6, s[20:23], s59 offen offset:896 lds
    v_mul_f32 v138, s90, v138
    v_mul_f32 v139, s90, v139
    v_mfma_f32_32x32x16_bf16 a[160:175], a[12:15], v[116:119], a[160:175]
    s_waitcnt lgkmcnt(4)
    ds_read_b64_tr_b16 a[4:5], v5 offset:4160
    ds_read_b64_tr_b16 a[6:7], v5 offset:4384
    buffer_load_dwordx4 v13, s[20:23], s59 offen offset:1792 lds
    v_cvt_pk_bf16_f32 v133, v138, v139
    v_mul_f32 v140, s90, v140
    v_mfma_f32_32x32x16_bf16 a[160:175], a[16:19], v[120:123], a[160:175]
    s_waitcnt lgkmcnt(4)
    ds_read_b64_tr_b16 a[8:9], v5 offset:5056
    ds_read_b64_tr_b16 a[10:11], v5 offset:5280
    buffer_load_dwordx4 v8, s[20:23], s59 offen offset:2688 lds
    s_add_u32 m0, s45, 25984
    v_mul_f32 v141, s90, v141
    v_mfma_f32_32x32x16_bf16 a[160:175], a[20:23], v[124:127], a[160:175]
    s_waitcnt lgkmcnt(4)
    ds_read_b64_tr_b16 a[12:13], v5 offset:5952
    ds_read_b64_tr_b16 a[14:15], v5 offset:6176
    buffer_load_dwordx4 v7, s[20:23], s60 offen offset:0 lds
    v_cvt_pk_bf16_f32 v134, v140, v141
    v_mul_f32 v142, s90, v142
    v_mfma_f32_32x32x16_bf16 a[176:191], a[0:3], v[112:115], a[176:191]
    s_waitcnt lgkmcnt(4)
    s_waitcnt vmcnt(15) lgkmcnt(0)
    s_barrier
    ds_read_b64_tr_b16 a[16:17], v5 offset:7424
    ds_read_b64_tr_b16 a[18:19], v5 offset:7648
    buffer_load_dwordx4 v6, s[20:23], s60 offen offset:896 lds
    v_mul_f32 v143, s90, v143
    v_cvt_pk_bf16_f32 v135, v142, v143
    v_mfma_f32_32x32x16_bf16 a[176:191], a[4:7], v[116:119], a[176:191]
    ds_read_b64_tr_b16 a[20:21], v5 offset:7488
    ds_read_b64_tr_b16 a[22:23], v5 offset:7712
    buffer_load_dwordx4 v13, s[20:23], s60 offen offset:1792 lds
    v_cndmask_b32 v134, v134, 0, s[94:95]
    v_cndmask_b32 v135, v135, 0, s[94:95]
    v_mfma_f32_32x32x16_bf16 a[176:191], a[8:11], v[120:123], a[176:191]
    ds_read_b64_tr_b16 a[0:1], v5 offset:7552
    ds_read_b64_tr_b16 a[2:3], v5 offset:7776
    buffer_load_dwordx4 v8, s[20:23], s60 offen offset:2688 lds
    s_add_u32 m0, s45, 29696
    v_add_u32 v10, s45, v1
    v_mfma_f32_32x32x16_bf16 a[176:191], a[12:15], v[124:127], a[176:191]
    s_waitcnt lgkmcnt(4)
    ds_read_b64_tr_b16 a[4:5], v5 offset:7616
    ds_read_b64_tr_b16 a[6:7], v5 offset:7840
    buffer_load_dwordx4 v7, s[20:23], s61 offen offset:0 lds
    v_accvgpr_read_b32 v7, a252
    v_add_u32 v2, s89, v1
WPAD27:
    s_cbranch_execz WRET0
    v_mfma_f32_32x32x16_bf16 v[176:191], a[16:19], v[16:19], 0
    s_waitcnt lgkmcnt(4)
    buffer_load_dwordx4 v6, s[20:23], s61 offen offset:896 lds
    v_add_u32 v6, 13440, v7
    v_add_u32 v3, s92, v1
    v_add_u32 v4, s84, v1
    v_and_b32 v9, 12, v14
    v_mfma_f32_32x32x16_bf16 v[192:207], a[20:23], v[16:19], 0
    s_waitcnt lgkmcnt(2)
    buffer_load_dwordx4 v13, s[20:23], s61 offen offset:1792 lds
    v_add_u32 v13, 26880, v7
    v_accvgpr_read_b32 v168, a128
    v_accvgpr_read_b32 v169, a129
    v_exp_f32 v248, -v168
    v_mfma_f32_32x32x16_bf16 v[208:223], a[0:3], v[16:19], 0
    s_waitcnt lgkmcnt(0)
    ds_read_b64_tr_b16 a[16:17], v5 offset:8320
    ds_read_b64_tr_b16 a[18:19], v5 offset:8544
    buffer_load_dwordx4 v8, s[20:23], s61 offen offset:2688 lds
    v_add_u32 v8, 40320, v7
    v_exp_f32 v249, -v169
    v_mfma_f32_32x32x16_bf16 v[224:239], a[4:7], v[16:19], 0
    ds_read_b64_tr_b16 a[20:21], v5 offset:8384
    ds_read_b64_tr_b16 a[22:23], v5 offset:8608
    v_fma_f32 v248, v248, s91, s91
    v_fma_f32 v249, v249, s91, s91
    v_rcp_f32 v248, v248
    v_mfma_f32_32x32x16_bf16 v[144:159], v[240:243], v[128:131], 0
    ds_read_b64_tr_b16 a[0:1], v5 offset:8448
    ds_read_b64_tr_b16 a[2:3], v5 offset:8672
    v_rcp_f32 v249, v249
    v_mul_f32 v168, v168, v248
    v_mul_f32 v169, v169, v249
    v_mfma_f32_32x32x16_bf16 v[144:159], v[244:247], v[132:135], v[144:159]
    s_waitcnt lgkmcnt(4)
    ds_read_b64_tr_b16 a[4:5], v5 offset:8512
    ds_read_b64_tr_b16 a[6:7], v5 offset:8736
    ds_write_b128 v10, v[128:131]
    v_accvgpr_read_b32 v170, a130
    v_accvgpr_read_b32 v171, a131
    v_exp_f32 v250, -v170
    v_mfma_f32_32x32x16_bf16 v[176:191], a[16:19], v[20:23], v[176:191]
    s_waitcnt lgkmcnt(5)
    ds_read_b64_tr_b16 a[8:9], v5 offset:9216
    ds_read_b64_tr_b16 a[10:11], v5 offset:9440
    v_exp_f32 v251, -v171
    v_fma_f32 v250, v250, s91, s91
    v_fma_f32 v251, v251, s91, s91
    v_mfma_f32_32x32x16_bf16 v[192:207], a[20:23], v[20:23], v[192:207]
    s_waitcnt lgkmcnt(5)
    ds_read_b64_tr_b16 a[12:13], v5 offset:9280
    ds_read_b64_tr_b16 a[14:15], v5 offset:9504
    v_max3_f32 v144, v144, v145, v146
    v_max3_f32 v147, v147, v148, v149
    v_max3_f32 v150, v150, v151, v152
    v_max3_f32 v153, v153, v154, v155
    v_mfma_f32_32x32x16_bf16 v[208:223], a[0:3], v[20:23], v[208:223]
    s_waitcnt lgkmcnt(5)
    ds_read_b64_tr_b16 a[16:17], v5 offset:9344
    ds_read_b64_tr_b16 a[18:19], v5 offset:9568
    v_max3_f32 v156, v156, v157, v158
    v_max3_f32 v144, v144, v147, v150
    v_max3_f32 v153, v153, v156, v159
    v_max_f32 v144, v144, v153
    v_mfma_f32_32x32x16_bf16 v[224:239], a[4:7], v[20:23], v[224:239]
    s_waitcnt lgkmcnt(4)
    ds_read_b64_tr_b16 a[20:21], v5 offset:9408
    ds_read_b64_tr_b16 a[22:23], v5 offset:9632
    v_mov_b32 v145, v144
    v_rcp_f32 v250, v250
    v_rcp_f32_e64 v251, v251
    v_mfma_f32_32x32x16_bf16 v[176:191], a[8:11], v[24:27], v[176:191]
    s_waitcnt lgkmcnt(4)
WPAD28:
    s_cbranch_execz WRET0
    ds_read_b64_tr_b16 a[0:1], v5 offset:10112
    ds_read_b64_tr_b16 a[2:3], v5 offset:10336
    v_permlane32_swap_b32 v144, v145
    v_max_f32 v144, v144, v145
    v_cvt_pk_bf16_f32 v144, -v144, 0
    v_cndmask_b32 v134, v134, v144, s[94:95]
    v_mfma_f32_32x32x16_bf16 v[192:207], a[12:15], v[24:27], v[192:207]
    s_waitcnt lgkmcnt(4)
    ds_read_b64_tr_b16 a[4:5], v5 offset:10176
    ds_read_b64_tr_b16 a[6:7], v5 offset:10400
    ds_write_b128 v10, v[132:135] offset:1024
    v_mul_f32 v170, v170, v250
    v_mul_f32 v171, v171, v251
    v_accvgpr_read_b32 v172, a132
    v_mfma_f32_32x32x16_bf16 v[208:223], a[16:19], v[24:27], v[208:223]
    s_waitcnt lgkmcnt(5)
    ds_read_b64_tr_b16 a[8:9], v5 offset:10240
    ds_read_b64_tr_b16 a[10:11], v5 offset:10464
    v_accvgpr_read_b32 v173, a133
    v_exp_f32 v248, -v172
    v_exp_f32 v249, -v173
    v_mfma_f32_32x32x16_bf16 v[224:239], a[20:23], v[24:27], v[224:239]
    s_waitcnt lgkmcnt(5)
    ds_read_b64_tr_b16 a[12:13], v5 offset:10304
    ds_read_b64_tr_b16 a[14:15], v5 offset:10528
    v_fma_f32 v248, v248, s91, s91
    v_fma_f32 v249, v249, s91, s91
    v_rcp_f32 v248, v248
    v_mfma_f32_32x32x16_bf16 v[176:191], a[0:3], v[28:31], v[176:191]
    s_waitcnt lgkmcnt(5)
    ds_read_b64_tr_b16 a[16:17], v5 offset:11136
    ds_read_b64_tr_b16 a[18:19], v5 offset:11360
    v_rcp_f32 v249, v249
    v_mul_f32 v172, v172, v248
    v_mul_f32 v173, v173, v249
    v_mfma_f32_32x32x16_bf16 v[192:207], a[4:7], v[28:31], v[192:207]
    s_waitcnt lgkmcnt(4)
    ds_read_b64_tr_b16 a[20:21], v5 offset:11200
    ds_read_b64_tr_b16 a[22:23], v5 offset:11424
    v_accvgpr_read_b32 v174, a134
    v_accvgpr_read_b32 v175, a135
    v_exp_f32 v250, -v174
    v_mfma_f32_32x32x16_bf16 v[208:223], a[8:11], v[28:31], v[208:223]
    s_waitcnt lgkmcnt(4)
    ds_read_b64_tr_b16 a[0:1], v5 offset:11264
    ds_read_b64_tr_b16 a[2:3], v5 offset:11488
    v_exp_f32 v251, -v175
    v_fma_f32 v250, v250, s91, s91
    v_fma_f32 v251, v251, s91, s91
    v_mfma_f32_32x32x16_bf16 v[224:239], a[12:15], v[28:31], v[224:239]
    s_waitcnt lgkmcnt(4)
    ds_read_b64_tr_b16 a[4:5], v5 offset:11328
    ds_read_b64_tr_b16 a[6:7], v5 offset:11552
    v_rcp_f32 v250, v250
    v_rcp_f32 v251, v251
    v_mfma_f32_32x32x16_bf16 v[176:191], a[16:19], v[32:35], v[176:191]
    s_waitcnt lgkmcnt(4)
    ds_read_b64_tr_b16 a[8:9], v5 offset:12032
    ds_read_b64_tr_b16 a[10:11], v5 offset:12256
    v_mul_f32 v174, v174, v250
    v_mul_f32_e64 v175, v175, v251
    v_accvgpr_read_b32 v136, a136
    v_accvgpr_read_b32 v137, a137
    v_mfma_f32_32x32x16_bf16 v[192:207], a[20:23], v[32:35], v[192:207]
    s_waitcnt lgkmcnt(4)
    ds_read_b64_tr_b16 a[12:13], v5 offset:12096
    ds_read_b64_tr_b16 a[14:15], v5 offset:12320
    v_exp_f32 v248, -v136
    v_exp_f32 v249, -v137
    v_mfma_f32_32x32x16_bf16 v[208:223], a[0:3], v[32:35], v[208:223]
    s_waitcnt lgkmcnt(4)
    ds_read_b64_tr_b16 a[16:17], v5 offset:12160
    ds_read_b64_tr_b16 a[18:19], v5 offset:12384
    v_fma_f32 v248, v248, s91, s91
WPAD29:
    s_cbranch_execz WRET0
    v_fma_f32 v249, v249, s91, s91
    v_rcp_f32 v248, v248
    v_mfma_f32_32x32x16_bf16 v[224:239], a[4:7], v[32:35], v[224:239]
    s_waitcnt lgkmcnt(4)
    ds_read_b64_tr_b16 a[20:21], v5 offset:12224
    ds_read_b64_tr_b16 a[22:23], v5 offset:12448
    v_rcp_f32 v249, v249
    v_mul_f32 v136, v136, v248
    v_mul_f32 v137, v137, v249
    v_mfma_f32_32x32x16_bf16 v[176:191], a[8:11], v[36:39], v[176:191]
    s_waitcnt lgkmcnt(4)
    ds_read_b64_tr_b16 a[0:1], v5 offset:12928
    ds_read_b64_tr_b16 a[2:3], v5 offset:13152
    v_accvgpr_read_b32 v138, a138
    v_accvgpr_read_b32 v139, a139
    v_exp_f32 v250, -v138
    v_mfma_f32_32x32x16_bf16 v[192:207], a[12:15], v[36:39], v[192:207]
    s_waitcnt lgkmcnt(4)
    ds_read_b64_tr_b16 a[4:5], v5 offset:12992
    ds_read_b64_tr_b16 a[6:7], v5 offset:13216
    v_exp_f32 v251, -v139
    v_fma_f32 v250, v250, s91, s91
    v_fma_f32 v251, v251, s91, s91
    v_mfma_f32_32x32x16_bf16 v[208:223], a[16:19], v[36:39], v[208:223]
    s_waitcnt lgkmcnt(4)
    s_waitcnt vmcnt(16)
    buffer_store_dword v12, v11, s[32:35], s67 offen sc1
    ds_read_b64_tr_b16 a[8:9], v5 offset:13056
    ds_read_b64_tr_b16 a[10:11], v5 offset:13280
    v_rcp_f32 v250, v250
    v_rcp_f32 v251, v251
    v_mfma_f32_32x32x16_bf16 v[224:239], a[20:23], v[36:39], v[224:239]
    s_waitcnt lgkmcnt(4)
    ds_read_b64_tr_b16 a[12:13], v5 offset:13120
    ds_read_b64_tr_b16 a[14:15], v5 offset:13344
    v_mul_f32 v138, v138, v250
    v_mul_f32 v139, v139, v251
    v_accvgpr_read_b32 v140, a140
    v_accvgpr_read_b32 v141, a141
    v_mfma_f32_32x32x16_bf16 v[176:191], a[0:3], v[40:43], v[176:191]
    s_waitcnt lgkmcnt(4)
    ds_read_b64_tr_b16 a[16:17], v5 offset:13824
    ds_read_b64_tr_b16 a[18:19], v5 offset:14048
    v_exp_f32 v248, -v140
    v_exp_f32 v249, -v141
    v_mfma_f32_32x32x16_bf16 v[192:207], a[4:7], v[40:43], v[192:207]
    s_waitcnt lgkmcnt(4)
    ds_read_b64_tr_b16 a[20:21], v5 offset:13888
    ds_read_b64_tr_b16 a[22:23], v5 offset:14112
    v_fma_f32 v248, v248, s91, s91
    v_fma_f32 v249, v249, s91, s91
    v_rcp_f32 v248, v248
    v_mfma_f32_32x32x16_bf16 v[208:223], a[8:11], v[40:43], v[208:223]
    s_waitcnt lgkmcnt(4)
    ds_read_b64_tr_b16 a[0:1], v5 offset:13952
    ds_read_b64_tr_b16 a[2:3], v5 offset:14176
    v_rcp_f32 v249, v249
    v_mul_f32 v140, v140, v248
    v_mul_f32_e64 v141, v141, v249
    v_mfma_f32_32x32x16_bf16 v[224:239], a[12:15], v[40:43], v[224:239]
    s_waitcnt lgkmcnt(4)
    ds_read_b64_tr_b16 a[4:5], v5 offset:14016
    ds_read_b64_tr_b16 a[6:7], v5 offset:14240
    v_accvgpr_read_b32 v142, a142
    v_accvgpr_read_b32 v143, a143
    v_exp_f32 v250, -v142
    v_mfma_f32_32x32x16_bf16 v[176:191], a[16:19], v[44:47], v[176:191]
    s_waitcnt lgkmcnt(4)
    ds_read_b64_tr_b16 a[8:9], v5 offset:14848
    ds_read_b64_tr_b16 a[10:11], v5 offset:15072
    v_exp_f32 v251, -v143
    v_fma_f32 v250, v250, s91, s91
    v_fma_f32 v251, v251, s91, s91
    v_mfma_f32_32x32x16_bf16 v[192:207], a[20:23], v[44:47], v[192:207]
    s_waitcnt lgkmcnt(4)
WPAD30:
    s_cbranch_execz WRET0
    ds_read_b64_tr_b16 a[12:13], v5 offset:14912
    ds_read_b64_tr_b16 a[14:15], v5 offset:15136
    v_rcp_f32 v250, v250
    v_rcp_f32 v251, v251
    v_mfma_f32_32x32x16_bf16 v[208:223], a[0:3], v[44:47], v[208:223]
    s_waitcnt lgkmcnt(4)
    ds_read_b64_tr_b16 a[16:17], v5 offset:14976
    ds_read_b64_tr_b16 a[18:19], v5 offset:15200
    v_mul_f32 v142, v142, v250
    v_mul_f32 v143, v143, v251
    v_accvgpr_read_b32 v160, a144
    v_accvgpr_read_b32 v161, a145
    v_mfma_f32_32x32x16_bf16 v[224:239], a[4:7], v[44:47], v[224:239]
    s_waitcnt lgkmcnt(4)
    ds_read_b64_tr_b16 a[20:21], v5 offset:15040
    ds_read_b64_tr_b16 a[22:23], v5 offset:15264
    v_exp_f32 v248, -v160
    v_exp_f32 v249, -v161
    v_mfma_f32_32x32x16_bf16 v[176:191], a[8:11], v[48:51], v[176:191]
    s_waitcnt lgkmcnt(4)
    ds_read_b64_tr_b16 a[0:1], v5 offset:15744
    ds_read_b64_tr_b16 a[2:3], v5 offset:15968
    v_fma_f32 v248, v248, s91, s91
    v_fma_f32 v249, v249, s91, s91
    v_rcp_f32 v248, v248
    v_mfma_f32_32x32x16_bf16 v[192:207], a[12:15], v[48:51], v[192:207]
    s_waitcnt lgkmcnt(4)
    ds_read_b64_tr_b16 a[4:5], v5 offset:15808
    ds_read_b64_tr_b16 a[6:7], v5 offset:16032
    v_rcp_f32 v249, v249
    v_mul_f32 v160, v160, v248
    v_mul_f32 v161, v161, v249
    v_mfma_f32_32x32x16_bf16 v[208:223], a[16:19], v[48:51], v[208:223]
    s_waitcnt lgkmcnt(4)
    ds_read_b64_tr_b16 a[8:9], v5 offset:15872
    ds_read_b64_tr_b16 a[10:11], v5 offset:16096
    v_accvgpr_read_b32 v162, a146
    v_accvgpr_read_b32 v163, a147
    v_exp_f32 v250, -v162
    v_mfma_f32_32x32x16_bf16 v[224:239], a[20:23], v[48:51], v[224:239]
    s_waitcnt lgkmcnt(4)
    ds_read_b64_tr_b16 a[12:13], v5 offset:15936
    ds_read_b64_tr_b16 a[14:15], v5 offset:16160
    v_exp_f32 v251, -v163
    v_fma_f32 v250, v250, s91, s91
    v_fma_f32 v251, v251, s91, s91
    v_mfma_f32_32x32x16_bf16 v[176:191], a[0:3], v[52:55], v[176:191]
    s_waitcnt lgkmcnt(4)
    ds_read_b64_tr_b16 a[16:17], v5 offset:16640
    ds_read_b64_tr_b16 a[18:19], v5 offset:16864
    v_rcp_f32 v250, v250
    v_rcp_f32 v251, v251
    v_mfma_f32_32x32x16_bf16 v[192:207], a[4:7], v[52:55], v[192:207]
    s_waitcnt lgkmcnt(4)
    ds_read_b64_tr_b16 a[20:21], v5 offset:16704
    ds_read_b64_tr_b16 a[22:23], v5 offset:16928
    v_mul_f32 v162, v162, v250
    v_mul_f32 v163, v163, v251
    v_accvgpr_read_b32 v164, a148
    v_accvgpr_read_b32 v165, a149
    v_mfma_f32_32x32x16_bf16 v[208:223], a[8:11], v[52:55], v[208:223]
    s_waitcnt lgkmcnt(4)
    ds_read_b64_tr_b16 a[0:1], v5 offset:16768
    ds_read_b64_tr_b16 a[2:3], v5 offset:16992
    v_exp_f32 v248, -v164
    v_exp_f32 v249, -v165
    v_mfma_f32_32x32x16_bf16 v[224:239], a[12:15], v[52:55], v[224:239]
    s_waitcnt lgkmcnt(4)
    ds_read_b64_tr_b16 a[4:5], v5 offset:16832
    ds_read_b64_tr_b16 a[6:7], v5 offset:17056
    v_fma_f32 v248, v248, s91, s91
    v_fma_f32 v249, v249, s91, s91
    v_rcp_f32_e64 v248, v248
    v_mfma_f32_32x32x16_bf16 v[176:191], a[16:19], v[56:59], v[176:191]
    s_waitcnt lgkmcnt(4)
WPAD31:
    s_cbranch_execz WRET0
    ds_read_b64_tr_b16 a[8:9], v5 offset:17536
    ds_read_b64_tr_b16 a[10:11], v5 offset:17760
    v_rcp_f32 v249, v249
    v_mul_f32 v164, v164, v248
    v_mul_f32 v165, v165, v249
    v_mfma_f32_32x32x16_bf16 v[192:207], a[20:23], v[56:59], v[192:207]
    s_waitcnt lgkmcnt(4)
    ds_read_b64_tr_b16 a[12:13], v5 offset:17600
    ds_read_b64_tr_b16 a[14:15], v5 offset:17824
    v_accvgpr_read_b32 v166, a150
    v_accvgpr_read_b32 v167, a151
    v_exp_f32 v250, -v166
    v_mfma_f32_32x32x16_bf16 v[208:223], a[0:3], v[56:59], v[208:223]
    s_waitcnt lgkmcnt(4)
    ds_read_b64_tr_b16 a[16:17], v5 offset:17664
    ds_read_b64_tr_b16 a[18:19], v5 offset:17888
    v_exp_f32 v251, -v167
    v_fma_f32 v250, v250, s91, s91
    v_fma_f32 v251, v251, s91, s91
    v_mfma_f32_32x32x16_bf16 v[224:239], a[4:7], v[56:59], v[224:239]
    s_waitcnt lgkmcnt(4)
    ds_read_b64_tr_b16 a[20:21], v5 offset:17728
    ds_read_b64_tr_b16 a[22:23], v5 offset:17952
    v_rcp_f32 v250, v250
    v_rcp_f32 v251, v251
    v_mfma_f32_32x32x16_bf16 v[176:191], a[8:11], v[60:63], v[176:191]
    s_waitcnt lgkmcnt(4)
    s_waitcnt vmcnt(9)
    s_barrier
    ds_read_b64_tr_b16 a[0:1], v5 offset:18560
    ds_read_b64_tr_b16 a[2:3], v5 offset:18784
    ds_read_b128 a[96:99], v2
    v_mul_f32 v166, v166, v250
    v_mul_f32 v167, v167, v251
    v_accvgpr_read_b32 v240, a152
    v_mfma_f32_32x32x16_bf16 v[192:207], a[12:15], v[60:63], v[192:207]
    s_waitcnt lgkmcnt(5)
    ds_read_b64_tr_b16 a[4:5], v5 offset:18624
    ds_read_b64_tr_b16 a[6:7], v5 offset:18848
    ds_read_b128 a[100:103], v2 offset:1024
    v_accvgpr_read_b32 v241, a153
    v_exp_f32 v248, -v240
    v_mfma_f32_32x32x16_bf16 v[208:223], a[16:19], v[60:63], v[208:223]
    s_waitcnt lgkmcnt(6)
    ds_read_b64_tr_b16 a[8:9], v5 offset:18688
    ds_read_b64_tr_b16 a[10:11], v5 offset:18912
    ds_read_b128 a[104:107], v3
    v_exp_f32 v249, -v241
    v_fma_f32 v248, v248, s91, s91
    v_mfma_f32_32x32x16_bf16 v[224:239], a[20:23], v[60:63], v[224:239]
    s_waitcnt lgkmcnt(7)
    ds_read_b64_tr_b16 a[12:13], v5 offset:18752
    ds_read_b64_tr_b16 a[14:15], v5 offset:18976
    ds_read_b128 a[108:111], v3 offset:1024
    v_fma_f32 v249, v249, s91, s91
    v_rcp_f32 v248, v248
    v_mfma_f32_32x32x16_bf16 v[176:191], a[0:3], v[64:67], v[176:191]
    s_waitcnt lgkmcnt(7)
    ds_read_b64_tr_b16 a[16:17], v5 offset:19456
    ds_read_b64_tr_b16 a[18:19], v5 offset:19680
    ds_read_b128 a[112:115], v4
    v_rcp_f32 v249, v249
    v_mul_f32 v240, v240, v248
    v_mfma_f32_32x32x16_bf16 v[192:207], a[4:7], v[64:67], v[192:207]
    s_waitcnt lgkmcnt(7)
    ds_read_b64_tr_b16 a[20:21], v5 offset:19520
    ds_read_b64_tr_b16 a[22:23], v5 offset:19744
    ds_read_b128 a[116:119], v4 offset:1024
    v_mul_f32 v241, v241, v249
    v_accvgpr_read_b32 v242, a154
    v_accvgpr_read_b32 v243, a155
    v_mfma_f32_32x32x16_bf16 v[208:223], a[8:11], v[64:67], v[208:223]
    s_waitcnt lgkmcnt(7)
    ds_read_b64_tr_b16 a[0:1], v5 offset:19584
    ds_read_b64_tr_b16 a[2:3], v5 offset:19808
WPAD32:
    s_cbranch_execz WRET0
    ds_read_b128 a[120:123], v10
    v_exp_f32 v250, -v242
    v_exp_f32 v251, -v243
    v_mfma_f32_32x32x16_bf16 v[224:239], a[12:15], v[64:67], v[224:239]
    s_waitcnt lgkmcnt(7)
    ds_read_b64_tr_b16 a[4:5], v5 offset:19648
    ds_read_b64_tr_b16 a[6:7], v5 offset:19872
    ds_read_b128 a[124:127], v10 offset:1024
    v_fma_f32 v250, v250, s91, s91
    v_fma_f32 v251, v251, s91, s91
    v_rcp_f32 v250, v250
    v_mfma_f32_32x32x16_bf16 v[176:191], a[16:19], v[68:71], v[176:191]
    s_waitcnt lgkmcnt(7)
    ds_read_b64_tr_b16 a[8:9], v5 offset:20352
    ds_read_b64_tr_b16 a[10:11], v5 offset:20576
    v_rcp_f32 v251, v251
    v_mul_f32 v242, v242, v250
    v_mul_f32 v243, v243, v251
    v_mfma_f32_32x32x16_bf16 v[192:207], a[20:23], v[68:71], v[192:207]
    s_waitcnt lgkmcnt(6)
    ds_read_b64_tr_b16 a[12:13], v5 offset:20416
    ds_read_b64_tr_b16 a[14:15], v5 offset:20640
    v_accvgpr_read_b32 v244, a156
    v_accvgpr_read_b32 v245, a157
    v_exp_f32 v248, -v244
    v_mfma_f32_32x32x16_bf16 v[208:223], a[0:3], v[68:71], v[208:223]
    s_waitcnt lgkmcnt(5)
    ds_read_b64_tr_b16 a[16:17], v5 offset:20480
    ds_read_b64_tr_b16 a[18:19], v5 offset:20704
    v_exp_f32 v249, -v245
    v_fma_f32 v248, v248, s91, s91
    v_fma_f32 v249, v249, s91, s91
    v_mfma_f32_32x32x16_bf16 v[224:239], a[4:7], v[68:71], v[224:239]
    s_waitcnt lgkmcnt(4)
    ds_read_b64_tr_b16 a[20:21], v5 offset:20544
    ds_read_b64_tr_b16 a[22:23], v5 offset:20768
    v_rcp_f32 v248, v248
    v_rcp_f32 v249, v249
    v_mfma_f32_32x32x16_bf16 v[176:191], a[8:11], v[72:75], v[176:191]
    s_waitcnt lgkmcnt(4)
    ds_read_b64_tr_b16 a[0:1], v5 offset:21248
    ds_read_b64_tr_b16 a[2:3], v5 offset:21472
    buffer_load_dword v252, v14, s[32:35], s68 offen sc1
    v_mul_f32 v244, v244, v248
    v_mul_f32 v245, v245, v249
    v_accvgpr_read_b32 v246, a158
    v_mfma_f32_32x32x16_bf16 v[192:207], a[12:15], v[72:75], v[192:207]
    s_waitcnt lgkmcnt(4)
    ds_read_b64_tr_b16 a[4:5], v5 offset:21312
    ds_read_b64_tr_b16 a[6:7], v5 offset:21536
    v_accvgpr_read_b32 v247, a159
    v_exp_f32 v250, -v246
    v_exp_f32 v251, -v247
    v_mfma_f32_32x32x16_bf16 v[208:223], a[16:19], v[72:75], v[208:223]
    s_waitcnt lgkmcnt(4)
    ds_read_b64_tr_b16 a[8:9], v5 offset:21376
    ds_read_b64_tr_b16 a[10:11], v5 offset:21600
    v_fma_f32 v250, v250, s91, s91
    v_fma_f32 v251, v251, s91, s91
    v_rcp_f32 v250, v250
    v_mfma_f32_32x32x16_bf16 v[224:239], a[20:23], v[72:75], v[224:239]
    s_waitcnt lgkmcnt(4)
    ds_read_b64_tr_b16 a[12:13], v5 offset:21440
    ds_read_b64_tr_b16 a[14:15], v5 offset:21664
    v_rcp_f32 v251, v251
    v_mul_f32 v246, v246, v250
    v_mul_f32_e64 v247, v247, v251
    v_mfma_f32_32x32x16_bf16 v[176:191], a[0:3], v[76:79], v[176:191]
    s_waitcnt lgkmcnt(4)
    ds_read_b64_tr_b16 a[16:17], v5 offset:22272
    ds_read_b64_tr_b16 a[18:19], v5 offset:22496
    v_accvgpr_read_b32 v144, a160
    v_accvgpr_read_b32 v145, a161
    v_exp_f32 v248, -v144
WPAD33:
    s_cbranch_execz WRET0
    v_mfma_f32_32x32x16_bf16 v[192:207], a[4:7], v[76:79], v[192:207]
    s_waitcnt lgkmcnt(4)
    ds_read_b64_tr_b16 a[20:21], v5 offset:22336
    ds_read_b64_tr_b16 a[22:23], v5 offset:22560
    v_exp_f32 v249, -v145
    v_fma_f32 v248, v248, s91, s91
    v_fma_f32 v249, v249, s91, s91
    v_mfma_f32_32x32x16_bf16 v[208:223], a[8:11], v[76:79], v[208:223]
    s_waitcnt lgkmcnt(4)
    ds_read_b64_tr_b16 a[0:1], v5 offset:22400
    ds_read_b64_tr_b16 a[2:3], v5 offset:22624
    v_rcp_f32 v248, v248
    v_rcp_f32 v249, v249
    v_mfma_f32_32x32x16_bf16 v[224:239], a[12:15], v[76:79], v[224:239]
    s_waitcnt lgkmcnt(4)
    ds_read_b64_tr_b16 a[4:5], v5 offset:22464
    ds_read_b64_tr_b16 a[6:7], v5 offset:22688
    v_mul_f32 v144, v144, v248
    v_mul_f32 v145, v145, v249
    v_accvgpr_read_b32 v146, a162
    v_accvgpr_read_b32 v147, a163
    v_mfma_f32_32x32x16_bf16 v[176:191], a[16:19], v[80:83], v[176:191]
    s_waitcnt lgkmcnt(4)
    ds_read_b64_tr_b16 a[8:9], v5 offset:23168
    ds_read_b64_tr_b16 a[10:11], v5 offset:23392
    v_exp_f32 v250, -v146
    v_exp_f32 v251, -v147
    v_mfma_f32_32x32x16_bf16 v[192:207], a[20:23], v[80:83], v[192:207]
    s_waitcnt lgkmcnt(4)
    ds_read_b64_tr_b16 a[12:13], v5 offset:23232
    ds_read_b64_tr_b16 a[14:15], v5 offset:23456
    v_fma_f32 v250, v250, s91, s91
    v_fma_f32 v251, v251, s91, s91
    v_rcp_f32 v250, v250
    v_mfma_f32_32x32x16_bf16 v[208:223], a[0:3], v[80:83], v[208:223]
    s_waitcnt lgkmcnt(4)
    ds_read_b64_tr_b16 a[16:17], v5 offset:23296
    ds_read_b64_tr_b16 a[18:19], v5 offset:23520
    v_rcp_f32 v251, v251
    v_mul_f32 v146, v146, v250
    v_mul_f32 v147, v147, v251
    v_mfma_f32_32x32x16_bf16 v[224:239], a[4:7], v[80:83], v[224:239]
    s_waitcnt lgkmcnt(4)
    ds_read_b64_tr_b16 a[20:21], v5 offset:23360
    ds_read_b64_tr_b16 a[22:23], v5 offset:23584
    v_accvgpr_read_b32 v148, a164
    v_accvgpr_read_b32 v149, a165
    v_exp_f32 v248, -v148
    v_mfma_f32_32x32x16_bf16 v[176:191], a[8:11], v[84:87], v[176:191]
    s_waitcnt lgkmcnt(4)
    ds_read_b64_tr_b16 a[0:1], v5 offset:24064
    ds_read_b64_tr_b16 a[2:3], v5 offset:24288
    v_exp_f32 v249, -v149
    v_fma_f32 v248, v248, s91, s91
    v_fma_f32 v249, v249, s91, s91
    v_mfma_f32_32x32x16_bf16 v[192:207], a[12:15], v[84:87], v[192:207]
    s_waitcnt lgkmcnt(4)
    ds_read_b64_tr_b16 a[4:5], v5 offset:24128
    ds_read_b64_tr_b16 a[6:7], v5 offset:24352
    v_rcp_f32 v248, v248
    v_rcp_f32 v249, v249
    v_mfma_f32_32x32x16_bf16 v[208:223], a[16:19], v[84:87], v[208:223]
    s_waitcnt lgkmcnt(4)
    ds_read_b64_tr_b16 a[8:9], v5 offset:24192
    ds_read_b64_tr_b16 a[10:11], v5 offset:24416
    v_mul_f32 v148, v148, v248
    v_mul_f32 v149, v149, v249
    v_accvgpr_read_b32 v150, a166
    v_accvgpr_read_b32 v151, a167
    v_mfma_f32_32x32x16_bf16 v[224:239], a[20:23], v[84:87], v[224:239]
    s_waitcnt lgkmcnt(4)
    ds_read_b64_tr_b16 a[12:13], v5 offset:24256
    ds_read_b64_tr_b16 a[14:15], v5 offset:24480
    v_exp_f32 v250, -v150
    v_exp_f32 v251, -v151
WPAD34:
    s_cbranch_execz WRET0
    v_mfma_f32_32x32x16_bf16 v[176:191], a[0:3], v[88:91], v[176:191]
    s_waitcnt lgkmcnt(4)
    ds_read_b64_tr_b16 a[16:17], v5 offset:24960
    ds_read_b64_tr_b16 a[18:19], v5 offset:25184
    v_fma_f32 v250, v250, s91, s91
    v_fma_f32 v251, v251, s91, s91
    v_rcp_f32 v250, v250
    v_mfma_f32_32x32x16_bf16 v[192:207], a[4:7], v[88:91], v[192:207]
    s_waitcnt lgkmcnt(4)
    ds_read_b64_tr_b16 a[20:21], v5 offset:25024
    ds_read_b64_tr_b16 a[22:23], v5 offset:25248
    v_rcp_f32 v251, v251
    v_mul_f32 v150, v150, v250
    v_mul_f32 v151, v151, v251
    v_mfma_f32_32x32x16_bf16 v[208:223], a[8:11], v[88:91], v[208:223]
    s_waitcnt lgkmcnt(4)
    ds_read_b64_tr_b16 a[0:1], v5 offset:25088
    ds_read_b64_tr_b16 a[2:3], v5 offset:25312
    v_accvgpr_read_b32 v152, a168
    v_accvgpr_read_b32 v153, a169
    v_exp_f32 v248, -v152
    v_mfma_f32_32x32x16_bf16 v[224:239], a[12:15], v[88:91], v[224:239]
    s_waitcnt lgkmcnt(4)
    ds_read_b64_tr_b16 a[4:5], v5 offset:25152
    ds_read_b64_tr_b16 a[6:7], v5 offset:25376
    v_exp_f32 v249, -v153
    v_fma_f32 v248, v248, s91, s91
    v_fma_f32 v249, v249, s91, s91
    v_mfma_f32_32x32x16_bf16 v[176:191], a[16:19], v[92:95], v[176:191]
    s_waitcnt lgkmcnt(4)
    s_waitcnt vmcnt(0)
    v_cmp_ne_u32 vcc, s46, v252
    s_cbranch_vccnz SPIN_KV
RET_KV:
    s_barrier
    ds_read_b64_tr_b16 a[8:9], v5 offset:25984
    ds_read_b64_tr_b16 a[10:11], v5 offset:26208
    buffer_load_dwordx4 a[32:35], v1, s[32:35], s69 offen offset:0 sc1
    v_rcp_f32 v248, v248
    v_rcp_f32 v249, v249
    v_mfma_f32_32x32x16_bf16 v[192:207], a[20:23], v[92:95], v[192:207]
    s_waitcnt lgkmcnt(4)
    ds_read_b64_tr_b16 a[12:13], v5 offset:26048
    ds_read_b64_tr_b16 a[14:15], v5 offset:26272
    buffer_load_dwordx4 a[36:39], v1, s[32:35], s69 offen offset:1024 sc1
    v_mul_f32 v152, v152, v248
    v_mul_f32 v153, v153, v249
    v_accvgpr_read_b32 v154, a170
    v_mfma_f32_32x32x16_bf16 v[208:223], a[0:3], v[92:95], v[208:223]
    s_waitcnt lgkmcnt(4)
    ds_read_b64_tr_b16 a[16:17], v5 offset:26112
    ds_read_b64_tr_b16 a[18:19], v5 offset:26336
    buffer_load_dwordx4 a[40:43], v1, s[32:35], s69 offen offset:2048 sc1
    v_accvgpr_read_b32 v155, a171
    v_exp_f32 v250, -v154
    v_mfma_f32_32x32x16_bf16 v[224:239], a[4:7], v[92:95], v[224:239]
    s_waitcnt lgkmcnt(4)
    ds_read_b64_tr_b16 a[20:21], v5 offset:26176
    ds_read_b64_tr_b16 a[22:23], v5 offset:26400
    buffer_load_dwordx4 a[44:47], v1, s[32:35], s69 offen offset:3072 sc1
    s_add_u32 s69, s69, 4096
    v_exp_f32 v251, -v155
    v_mfma_f32_32x32x16_bf16 v[176:191], a[8:11], v[96:99], v[176:191]
    s_waitcnt lgkmcnt(4)
    ds_read_b64_tr_b16 a[0:1], v5 offset:26880
    ds_read_b64_tr_b16 a[2:3], v5 offset:27104
    buffer_load_dwordx4 a[48:51], v1, s[32:35], s69 offen offset:0 sc1
    v_fma_f32 v250, v250, s91, s91
    v_fma_f32 v251, v251, s91, s91
    v_rcp_f32 v250, v250
    v_mfma_f32_32x32x16_bf16 v[192:207], a[12:15], v[96:99], v[192:207]
    s_waitcnt lgkmcnt(4)
    ds_read_b64_tr_b16 a[4:5], v5 offset:26944
    ds_read_b64_tr_b16 a[6:7], v5 offset:27168
    buffer_load_dwordx4 a[52:55], v1, s[32:35], s69 offen offset:1024 sc1
    v_rcp_f32 v251, v251
    v_mul_f32 v154, v154, v250
WPAD35:
    s_cbranch_execz WRET0
    v_mfma_f32_32x32x16_bf16 v[208:223], a[16:19], v[96:99], v[208:223]
    s_waitcnt lgkmcnt(4)
    ds_read_b64_tr_b16 a[8:9], v5 offset:27008
    ds_read_b64_tr_b16 a[10:11], v5 offset:27232
    buffer_load_dwordx4 a[56:59], v1, s[32:35], s69 offen offset:2048 sc1
    v_mul_f32 v155, v155, v251
    v_accvgpr_read_b32 v156, a172
    v_accvgpr_read_b32 v157, a173
    v_mfma_f32_32x32x16_bf16 v[224:239], a[20:23], v[96:99], v[224:239]
    s_waitcnt lgkmcnt(4)
    ds_read_b64_tr_b16 a[12:13], v5 offset:27072
    ds_read_b64_tr_b16 a[14:15], v5 offset:27296
    buffer_load_dwordx4 a[60:63], v1, s[32:35], s69 offen offset:3072 sc1
    s_add_u32 s69, s69, 4096
    v_exp_f32 v248, -v156
    v_mfma_f32_32x32x16_bf16 v[176:191], a[0:3], v[100:103], v[176:191]
    s_waitcnt lgkmcnt(4)
    ds_read_b64_tr_b16 a[16:17], v5 offset:27776
    ds_read_b64_tr_b16 a[18:19], v5 offset:28000
    buffer_load_dwordx4 a[64:67], v1, s[32:35], s69 offen offset:0 sc1
    v_exp_f32 v249, -v157
    v_fma_f32 v248, v248, s91, s91
    v_mfma_f32_32x32x16_bf16 v[192:207], a[4:7], v[100:103], v[192:207]
    s_waitcnt lgkmcnt(4)
    ds_read_b64_tr_b16 a[20:21], v5 offset:27840
    ds_read_b64_tr_b16 a[22:23], v5 offset:28064
    buffer_load_dwordx4 a[68:71], v1, s[32:35], s69 offen offset:1024 sc1
    v_fma_f32 v249, v249, s91, s91
    v_rcp_f32 v248, v248
    v_mfma_f32_32x32x16_bf16 v[208:223], a[8:11], v[100:103], v[208:223]
    s_waitcnt lgkmcnt(4)
    ds_read_b64_tr_b16 a[0:1], v5 offset:27904
    ds_read_b64_tr_b16 a[2:3], v5 offset:28128
    buffer_load_dwordx4 a[72:75], v1, s[32:35], s69 offen offset:2048 sc1
    v_rcp_f32 v249, v249
    v_mul_f32 v156, v156, v248
    v_mfma_f32_32x32x16_bf16 v[224:239], a[12:15], v[100:103], v[224:239]
    s_waitcnt lgkmcnt(4)
    ds_read_b64_tr_b16 a[4:5], v5 offset:27968
    ds_read_b64_tr_b16 a[6:7], v5 offset:28192
    buffer_load_dwordx4 a[76:79], v1, s[32:35], s69 offen offset:3072 sc1
    s_add_u32 s69, s69, 4096
    v_mul_f32 v157, v157, v249
    v_accvgpr_read_b32 v158, a174
    v_mfma_f32_32x32x16_bf16 v[176:191], a[16:19], v[104:107], v[176:191]
    s_waitcnt lgkmcnt(4)
    ds_read_b64_tr_b16 a[8:9], v5 offset:28672
    ds_read_b64_tr_b16 a[10:11], v5 offset:28896
    buffer_load_dwordx4 a[80:83], v1, s[32:35], s69 offen offset:0 sc1
    v_accvgpr_read_b32 v159, a175
    v_exp_f32 v250, -v158
    v_mfma_f32_32x32x16_bf16 v[192:207], a[20:23], v[104:107], v[192:207]
    s_waitcnt lgkmcnt(4)
    ds_read_b64_tr_b16 a[12:13], v5 offset:28736
    ds_read_b64_tr_b16 a[14:15], v5 offset:28960
    buffer_load_dwordx4 a[84:87], v1, s[32:35], s69 offen offset:1024 sc1
    v_exp_f32 v251, -v159
    v_fma_f32 v250, v250, s91, s91
    v_mfma_f32_32x32x16_bf16 v[208:223], a[0:3], v[104:107], v[208:223]
    s_waitcnt lgkmcnt(4)
    ds_read_b64_tr_b16 a[16:17], v5 offset:28800
    ds_read_b64_tr_b16 a[18:19], v5 offset:29024
    buffer_load_dwordx4 a[88:91], v1, s[32:35], s69 offen offset:2048 sc1
    v_fma_f32 v251, v251, s91, s91
    v_rcp_f32 v250, v250
    v_mfma_f32_32x32x16_bf16 v[224:239], a[4:7], v[104:107], v[224:239]
    s_waitcnt lgkmcnt(4)
    ds_read_b64_tr_b16 a[20:21], v5 offset:28864
    ds_read_b64_tr_b16 a[22:23], v5 offset:29088
    buffer_load_dwordx4 a[92:95], v1, s[32:35], s69 offen offset:3072 sc1
    s_add_u32 s69, s69, 4096
    v_rcp_f32 v251, v251
WPAD36:
    s_cbranch_execz WRET0
    v_mfma_f32_32x32x16_bf16 v[176:191], a[8:11], v[108:111], v[176:191]
    s_waitcnt lgkmcnt(4)
    ds_read_b64_tr_b16 a[0:1], v5 offset:29696
    ds_read_b64_tr_b16 a[2:3], v5 offset:29920
    v_mul_f32 v158, v158, v250
    v_mul_f32 v159, v159, v251
    v_accvgpr_read_b32 v128, a176
    v_accvgpr_read_b32 v129, a177
    v_mfma_f32_32x32x16_bf16 v[192:207], a[12:15], v[108:111], v[192:207]
    s_waitcnt lgkmcnt(4)
    ds_read_b64_tr_b16 a[4:5], v5 offset:30592
    ds_read_b64_tr_b16 a[6:7], v5 offset:30816
    v_exp_f32 v248, -v128
    v_exp_f32 v249, -v129
    v_mfma_f32_32x32x16_bf16 v[208:223], a[16:19], v[108:111], v[208:223]
    s_waitcnt lgkmcnt(4)
    ds_read_b64_tr_b16 a[8:9], v5 offset:31488
    ds_read_b64_tr_b16 a[10:11], v5 offset:31712
    v_fma_f32 v248, v248, s91, s91
    v_fma_f32 v249, v249, s91, s91
    v_rcp_f32 v248, v248
    v_mfma_f32_32x32x16_bf16 v[224:239], a[20:23], v[108:111], v[224:239]
    s_waitcnt lgkmcnt(4)
    ds_read_b64_tr_b16 a[12:13], v5 offset:32384
    ds_read_b64_tr_b16 a[14:15], v5 offset:32608
    v_rcp_f32 v249, v249
    v_mul_f32 v128, v128, v248
    v_mul_f32 v129, v129, v249
    v_mfma_f32_32x32x16_bf16 v[176:191], a[0:3], v[112:115], v[176:191]
    s_waitcnt lgkmcnt(4)
    ds_read_b64_tr_b16 a[16:17], v5 offset:29760
    ds_read_b64_tr_b16 a[18:19], v5 offset:29984
    v_accvgpr_read_b32 v130, a178
    v_accvgpr_read_b32 v131, a179
    v_exp_f32 v250, -v130
    v_mfma_f32_32x32x16_bf16 v[176:191], a[4:7], v[116:119], v[176:191]
    s_waitcnt lgkmcnt(4)
    ds_read_b64_tr_b16 a[20:21], v5 offset:30656
    ds_read_b64_tr_b16 a[22:23], v5 offset:30880
    v_exp_f32 v251, -v131
    v_fma_f32 v250, v250, s91, s91
    v_fma_f32 v251, v251, s91, s91
    v_mfma_f32_32x32x16_bf16 v[176:191], a[8:11], v[120:123], v[176:191]
    s_waitcnt lgkmcnt(4)
    ds_read_b64_tr_b16 a[0:1], v5 offset:31552
    ds_read_b64_tr_b16 a[2:3], v5 offset:31776
    v_rcp_f32 v250, v250
    v_rcp_f32 v251, v251
    v_mfma_f32_32x32x16_bf16 v[176:191], a[12:15], v[124:127], v[176:191]
    s_waitcnt lgkmcnt(4)
    ds_read_b64_tr_b16 a[4:5], v5 offset:32448
    ds_read_b64_tr_b16 a[6:7], v5 offset:32672
    v_mul_f32 v130, v130, v250
    v_mul_f32 v131, v131, v251
    v_accvgpr_read_b32 v132, a180
    v_accvgpr_read_b32 v133, a181
    v_mfma_f32_32x32x16_bf16 v[192:207], a[16:19], v[112:115], v[192:207]
    s_waitcnt lgkmcnt(4)
    ds_read_b64_tr_b16 a[8:9], v5 offset:29824
    ds_read_b64_tr_b16 a[10:11], v5 offset:30048
    v_exp_f32 v248, -v132
    v_exp_f32 v249, -v133
    v_mfma_f32_32x32x16_bf16 v[192:207], a[20:23], v[116:119], v[192:207]
    s_waitcnt lgkmcnt(4)
    ds_read_b64_tr_b16 a[12:13], v5 offset:30720
    ds_read_b64_tr_b16 a[14:15], v5 offset:30944
    v_mul_f32 v176, v168, v176
    v_mul_f32 v177, v169, v177
    v_cvt_pk_bf16_f32 v176, v176, v177
    v_mul_f32 v178, v170, v178
    v_mfma_f32_32x32x16_bf16 v[192:207], a[0:3], v[120:123], v[192:207]
    s_waitcnt lgkmcnt(4)
    ds_read_b64_tr_b16 a[16:17], v5 offset:31616
    ds_read_b64_tr_b16 a[18:19], v5 offset:31840
    v_mul_f32 v179, v171, v179
    v_cvt_pk_bf16_f32 v177, v178, v179
WPAD37:
    s_cbranch_execz WRET0
    v_mul_f32 v180, v172, v180
    v_mul_f32 v181, v173, v181
    v_mfma_f32_32x32x16_bf16 v[192:207], a[4:7], v[124:127], v[192:207]
    s_waitcnt lgkmcnt(4)
    ds_read_b64_tr_b16 a[20:21], v5 offset:32512
    ds_read_b64_tr_b16 a[22:23], v5 offset:32736
    v_cvt_pk_bf16_f32 v178, v180, v181
    v_mul_f32 v182, v174, v182
    v_mul_f32 v183, v175, v183
    v_cvt_pk_bf16_f32 v179, v182, v183
    v_mfma_f32_32x32x16_bf16 v[208:223], a[8:11], v[112:115], v[208:223]
    s_waitcnt lgkmcnt(4)
    ds_read_b64_tr_b16 a[0:1], v5 offset:29888
    ds_read_b64_tr_b16 a[2:3], v5 offset:30112
    buffer_store_dwordx4 v[176:179], v1, s[32:35], s70 offen offset:0 sc1
    v_mul_f32 v184, v136, v184
    v_mul_f32 v185, v137, v185
    v_cvt_pk_bf16_f32 v180, v184, v185
    v_mfma_f32_32x32x16_bf16 v[208:223], a[12:15], v[116:119], v[208:223]
    s_waitcnt lgkmcnt(4)
    ds_read_b64_tr_b16 a[4:5], v5 offset:30784
    ds_read_b64_tr_b16 a[6:7], v5 offset:31008
    v_mul_f32 v186, v138, v186
    v_mul_f32 v187, v139, v187
    v_cvt_pk_bf16_f32 v181, v186, v187
    v_mul_f32 v188, v140, v188
    v_mfma_f32_32x32x16_bf16 v[208:223], a[16:19], v[120:123], v[208:223]
    s_waitcnt lgkmcnt(4)
    ds_read_b64_tr_b16 a[8:9], v5 offset:31680
    ds_read_b64_tr_b16 a[10:11], v5 offset:31904
    v_mul_f32 v189, v141, v189
    v_cvt_pk_bf16_f32 v182, v188, v189
    v_mul_f32 v190, v142, v190
    v_mul_f32 v191, v143, v191
    v_mfma_f32_32x32x16_bf16 v[208:223], a[20:23], v[124:127], v[208:223]
    s_waitcnt lgkmcnt(4)
    ds_read_b64_tr_b16 a[12:13], v5 offset:32576
    ds_read_b64_tr_b16 a[14:15], v5 offset:32800
    v_cvt_pk_bf16_f32 v183, v190, v191
    v_mul_f32 v192, v160, v192
    v_mul_f32 v193, v161, v193
    v_cvt_pk_bf16_f32 v192, v192, v193
    v_mfma_f32_32x32x16_bf16 v[224:239], a[0:3], v[112:115], v[224:239]
    s_waitcnt lgkmcnt(4)
    buffer_store_dwordx4 v[180:183], v1, s[32:35], s70 offen offset:1024 sc1
    v_mul_f32 v194, v162, v194
    v_mul_f32 v195, v163, v195
    v_cvt_pk_bf16_f32 v193, v194, v195
    v_mul_f32 v196, v164, v196
    v_mul_f32 v197, v165, v197
    v_mfma_f32_32x32x16_bf16 v[224:239], a[4:7], v[116:119], v[224:239]
    s_waitcnt lgkmcnt(2)
    v_cvt_pk_bf16_f32 v194, v196, v197
    v_mul_f32 v198, v166, v198
    v_mul_f32 v199, v167, v199
    v_cvt_pk_bf16_f32 v195, v198, v199
    v_mul_f32 v200, v240, v200
    v_mul_f32 v201, v241, v201
    v_mfma_f32_32x32x16_bf16 v[224:239], a[8:11], v[120:123], v[224:239]
    s_waitcnt lgkmcnt(0)
    buffer_store_dwordx4 v[192:195], v1, s[32:35], s70 offen offset:2048 sc1
    v_cvt_pk_bf16_f32 v196, v200, v201
    v_mul_f32 v202, v242, v202
    v_mul_f32 v203, v243, v203
    v_cvt_pk_bf16_f32 v197, v202, v203
    v_mul_f32 v204, v244, v204
    v_mfma_f32_32x32x16_bf16 v[224:239], a[12:15], v[124:127], v[224:239]
    v_mul_f32 v205, v245, v205
    v_cvt_pk_bf16_f32 v198, v204, v205
    v_mul_f32 v206, v246, v206
    v_mul_f32 v207, v247, v207
    v_cvt_pk_bf16_f32 v199, v206, v207
    v_accvgpr_read_b32 v5, a253
    s_waitcnt vmcnt(18)
    v_mfma_f32_32x32x16_bf16 v[16:31], a[32:35], a[96:99], 0
    s_waitcnt vmcnt(17)
    v_mfma_f32_32x32x16_bf16 v[16:31], a[36:39], a[100:103], v[16:31]
    v_fma_f32 v248, v248, s91, s91
    v_fma_f32 v249, v249, s91, s91
    v_rcp_f32 v248, v248
    v_rcp_f32 v249, v249
    v_mul_f32 v132, v132, v248
    v_mul_f32_e64 v133, v133, v249
    v_accvgpr_read_b32 v134, a182
WPAD38:
    s_cbranch_execz WRET0
    v_accvgpr_read_b32 v135, a183
    v_exp_f32 v250, -v134
    v_exp_f32 v251, -v135
    v_fma_f32 v250, v250, s91, s91
    v_fma_f32 v251, v251, s91, s91
    v_rcp_f32 v250, v250
    v_rcp_f32 v251, v251
    v_mul_f32 v134, v134, v250
    v_mul_f32 v135, v135, v251
    v_mul_f32 v208, v144, v208
    v_mul_f32 v209, v145, v209
    v_cvt_pk_bf16_f32 v208, v208, v209
    v_mul_f32 v210, v146, v210
    v_mul_f32 v211, v147, v211
    v_cvt_pk_bf16_f32 v209, v210, v211
    v_mul_f32 v212, v148, v212
    v_mul_f32 v213, v149, v213
    v_cvt_pk_bf16_f32 v210, v212, v213
    v_mul_f32 v214, v150, v214
    v_mul_f32 v215, v151, v215
    v_cvt_pk_bf16_f32 v211, v214, v215
    v_mul_f32 v216, v152, v216
    v_mul_f32 v217, v153, v217
    v_cvt_pk_bf16_f32 v212, v216, v217
    v_mul_f32 v218, v154, v218
    v_mul_f32 v219, v155, v219
    v_cvt_pk_bf16_f32 v213, v218, v219
    v_mul_f32 v220, v156, v220
    v_mul_f32 v221, v157, v221
    v_cvt_pk_bf16_f32 v214, v220, v221
    v_mul_f32 v222, v158, v222
    v_mul_f32 v223, v159, v223
    v_cvt_pk_bf16_f32 v215, v222, v223
    v_mul_f32 v224, v128, v224
    v_mul_f32 v225, v129, v225
    v_cvt_pk_bf16_f32 v224, v224, v225
    v_mul_f32 v226, v130, v226
    v_mul_f32 v227, v131, v227
    v_cvt_pk_bf16_f32 v225, v226, v227
    v_mul_f32 v228, v132, v228
    v_mul_f32 v229, v133, v229
    v_cvt_pk_bf16_f32 v226, v228, v229
    v_mul_f32 v230, v134, v230
    v_mul_f32 v231, v135, v231
    v_cvt_pk_bf16_f32 v227, v230, v231
    v_exp_f32 v16, v16
    v_exp_f32 v17, v17
    v_mfma_f32_32x32x16_bf16 v[32:47], a[32:35], a[104:107], 0
    buffer_store_dwordx4 v[196:199], v1, s[32:35], s70 offen offset:3072 sc1
    buffer_store_dwordx4 v[208:211], v1, s[32:35], s71 offen offset:0 sc1
    v_exp_f32 v18, v18
    v_exp_f32 v19, v19
    v_cvt_pk_bf16_f32 v48, v16, v17
    v_exp_f32 v20, v20
    v_exp_f32 v21, v21
    v_cvt_pk_bf16_f32 v49, v18, v19
    v_mfma_f32_32x32x16_bf16 v[32:47], a[36:39], a[108:111], v[32:47]
    buffer_store_dwordx4 v[212:215], v1, s[32:35], s71 offen offset:1024 sc1
    buffer_store_dwordx4 v[224:227], v1, s[32:35], s71 offen offset:2048 sc1
    v_exp_f32 v22, v22
    v_exp_f32 v23, v23
    v_cvt_pk_bf16_f32 v50, v20, v21
    v_exp_f32 v24, v24
    v_exp_f32 v25, v25
    v_cvt_pk_bf16_f32 v51, v22, v23
    v_exp_f32 v26, v26
    v_exp_f32 v27, v27
    v_cvt_pk_bf16_f32 v52, v24, v25
    v_exp_f32 v28, v28
    v_exp_f32 v29, v29
    v_cvt_pk_bf16_f32 v53, v26, v27
    v_exp_f32 v30, v30
    v_exp_f32 v31, v31
    v_cvt_pk_bf16_f32 v54, v28, v29
    v_exp_f32 v32, v32
    v_exp_f32 v33, v33
    v_cvt_pk_bf16_f32 v55, v30, v31
    v_mfma_f32_32x32x16_bf16 v[16:31], a[32:35], a[112:115], 0
    buffer_load_dwordx4 a[192:195], v1, s[32:35], s69 offen offset:0 sc1
    s_add_u32 m0, s45, 33408
    v_exp_f32 v34, v34
    v_exp_f32 v35, v35
    v_cvt_pk_bf16_f32 v56, v32, v33
    v_exp_f32 v36, v36
    v_exp_f32 v37, v37
    v_cvt_pk_bf16_f32 v57, v34, v35
    v_mfma_f32_32x32x16_bf16 v[16:31], a[36:39], a[116:119], v[16:31]
    s_waitcnt vmcnt(21)
    buffer_load_dwordx4 v7, s[24:27], s64 offen offset:0 lds
WPAD39:
    s_cbranch_execz WRET0
    buffer_load_dwordx4 v6, s[24:27], s64 offen offset:896 lds
    v_exp_f32 v38, v38
    v_exp_f32 v39, v39
    v_cvt_pk_bf16_f32 v58, v36, v37
    v_exp_f32 v40, v40
    v_exp_f32 v41, v41
    v_cvt_pk_bf16_f32 v59, v38, v39
    v_mfma_f32_32x32x16_bf16 a[128:143], a[40:43], v[48:51], 0
    s_waitcnt vmcnt(22)
    buffer_load_dwordx4 a[196:199], v1, s[32:35], s69 offen offset:1024 sc1
    buffer_load_dwordx4 v13, s[24:27], s64 offen offset:1792 lds
    v_exp_f32 v42, v42
    v_exp_f32 v43, v43
    v_cvt_pk_bf16_f32 v60, v40, v41
    v_exp_f32 v44, v44
    v_exp_f32 v45, v45
    v_cvt_pk_bf16_f32 v61, v42, v43
    v_mfma_f32_32x32x16_bf16 a[128:143], a[44:47], v[52:55], a[128:143]
    v_exp_f32 v46, v46
    v_exp_f32 v47, v47
    v_cvt_pk_bf16_f32 v62, v44, v45
    v_exp_f32 v16, v16
    v_exp_f32 v17, v17
    v_cvt_pk_bf16_f32 v63, v46, v47
    v_mfma_f32_32x32x16_bf16 v[32:47], a[32:35], a[120:123], 0
    buffer_load_dwordx4 a[200:203], v1, s[32:35], s69 offen offset:2048 sc1
    v_exp_f32 v18, v18
    v_exp_f32 v19, v19
    v_cvt_pk_bf16_f32 v48, v16, v17
    v_exp_f32 v20, v20
    v_exp_f32 v21, v21
    v_cvt_pk_bf16_f32 v49, v18, v19
    v_mfma_f32_32x32x16_bf16 v[32:47], a[36:39], a[124:127], v[32:47]
    buffer_load_dwordx4 v8, s[24:27], s64 offen offset:2688 lds
    s_add_u32 s64, s64, 57344
    v_exp_f32 v22, v22
    v_exp_f32 v23, v23
    v_cvt_pk_bf16_f32 v50, v20, v21
    v_exp_f32 v24, v24
    v_exp_f32 v25, v25
    v_cvt_pk_bf16_f32 v51, v22, v23
    v_mfma_f32_32x32x16_bf16 a[144:159], a[40:43], v[56:59], 0
    v_exp_f32 v26, v26
    v_exp_f32 v27, v27
    v_cvt_pk_bf16_f32 v52, v24, v25
    v_exp_f32 v28, v28
    v_exp_f32 v29, v29
    v_cvt_pk_bf16_f32 v53, v26, v27
    v_mfma_f32_32x32x16_bf16 a[144:159], a[44:47], v[60:63], a[144:159]
    s_waitcnt vmcnt(25)
    v_exp_f32 v30, v30
    v_exp_f32 v31, v31
    v_cvt_pk_bf16_f32 v54, v28, v29
    v_exp_f32 v32, v32
    v_exp_f32 v33, v33
    v_cvt_pk_bf16_f32 v55, v30, v31
    v_mfma_f32_32x32x16_bf16 v[16:31], a[48:51], a[96:99], 0
    s_waitcnt vmcnt(24)
    buffer_load_dwordx4 a[204:207], v1, s[32:35], s69 offen offset:3072 sc1
    s_add_u32 s69, s69, 4096
    v_exp_f32 v34, v34
    v_exp_f32 v35, v35
    v_cvt_pk_bf16_f32 v56, v32, v33
    v_exp_f32 v36, v36
    v_exp_f32 v37, v37
    v_cvt_pk_bf16_f32 v57, v34, v35
    v_mfma_f32_32x32x16_bf16 v[16:31], a[52:55], a[100:103], v[16:31]
    s_add_u32 m0, s45, 37120
    s_nop 0
    buffer_load_dwordx4 v7, s[24:27], s64 offen offset:0 lds
    v_exp_f32 v38, v38
    v_exp_f32 v39, v39
    v_cvt_pk_bf16_f32 v58, v36, v37
    v_exp_f32 v40, v40
    v_exp_f32 v41, v41
    v_cvt_pk_bf16_f32 v59, v38, v39
    v_mfma_f32_32x32x16_bf16 a[160:175], a[40:43], v[48:51], 0
    buffer_load_dwordx4 v6, s[24:27], s64 offen offset:896 lds
    v_exp_f32 v42, v42
    v_exp_f32 v43, v43
    v_cvt_pk_bf16_f32 v60, v40, v41
    v_exp_f32 v44, v44
    v_exp_f32 v45, v45
    v_cvt_pk_bf16_f32 v61, v42, v43
    v_mfma_f32_32x32x16_bf16 a[160:175], a[44:47], v[52:55], a[160:175]
    v_exp_f32 v46, v46
WPAD40:
    s_cbranch_execz WRET0
    v_exp_f32 v47, v47
    v_cvt_pk_bf16_f32 v62, v44, v45
    v_exp_f32 v16, v16
    v_exp_f32 v17, v17
    v_cvt_pk_bf16_f32 v63, v46, v47
    v_mfma_f32_32x32x16_bf16 v[32:47], a[48:51], a[104:107], 0
    buffer_load_dwordx4 a[208:211], v1, s[32:35], s69 offen offset:0 sc1
    v_exp_f32 v18, v18
    v_exp_f32 v19, v19
    v_cvt_pk_bf16_f32 v48, v16, v17
    v_exp_f32 v20, v20
    v_exp_f32 v21, v21
    v_cvt_pk_bf16_f32 v49, v18, v19
    v_mfma_f32_32x32x16_bf16 v[32:47], a[52:55], a[108:111], v[32:47]
    buffer_load_dwordx4 v13, s[24:27], s64 offen offset:1792 lds
    v_exp_f32 v22, v22
    v_exp_f32 v23, v23
    v_cvt_pk_bf16_f32 v50, v20, v21
    v_exp_f32 v24, v24
    v_exp_f32 v25, v25
    v_cvt_pk_bf16_f32 v51, v22, v23
    v_mfma_f32_32x32x16_bf16 v[64:79], a[40:43], v[56:59], 0
    v_exp_f32 v26, v26
    v_exp_f32 v27, v27
    v_cvt_pk_bf16_f32 v52, v24, v25
    v_exp_f32 v28, v28
    v_exp_f32 v29, v29
    v_cvt_pk_bf16_f32 v53, v26, v27
    v_mfma_f32_32x32x16_bf16 v[64:79], a[44:47], v[60:63], v[64:79]
    v_exp_f32 v30, v30
    v_exp_f32 v31, v31
    v_cvt_pk_bf16_f32 v54, v28, v29
    v_exp_f32 v32, v32
    v_exp_f32 v33, v33
    v_cvt_pk_bf16_f32 v55, v30, v31
    v_mfma_f32_32x32x16_bf16 v[16:31], a[48:51], a[112:115], 0
    buffer_load_dwordx4 a[212:215], v1, s[32:35], s69 offen offset:1024 sc1
    v_exp_f32 v34, v34
    v_exp_f32 v35, v35
    v_cvt_pk_bf16_f32 v56, v32, v33
    v_exp_f32 v36, v36
    v_exp_f32 v37, v37
    v_cvt_pk_bf16_f32 v57, v34, v35
    v_mfma_f32_32x32x16_bf16 v[16:31], a[52:55], a[116:119], v[16:31]
    s_waitcnt vmcnt(29)
    buffer_load_dwordx4 v8, s[24:27], s64 offen offset:2688 lds
    s_add_u32 s64, s64, 57344
    v_exp_f32 v38, v38
    v_exp_f32 v39, v39
    v_cvt_pk_bf16_f32 v58, v36, v37
    v_exp_f32 v40, v40
    v_exp_f32 v41, v41
    v_cvt_pk_bf16_f32 v59, v38, v39
    v_mfma_f32_32x32x16_bf16 a[128:143], a[56:59], v[48:51], a[128:143]
    s_waitcnt vmcnt(29)
    v_exp_f32 v42, v42
    v_exp_f32 v43, v43
    v_cvt_pk_bf16_f32 v60, v40, v41
    v_exp_f32 v44, v44
    v_exp_f32 v45, v45
    v_cvt_pk_bf16_f32 v61, v42, v43
    v_mfma_f32_32x32x16_bf16 a[128:143], a[60:63], v[52:55], a[128:143]
    v_exp_f32 v46, v46
    v_exp_f32 v47, v47
    v_cvt_pk_bf16_f32 v62, v44, v45
    v_exp_f32 v16, v16
    v_exp_f32 v17, v17
    v_cvt_pk_bf16_f32 v63, v46, v47
    v_mfma_f32_32x32x16_bf16 v[32:47], a[48:51], a[120:123], 0
    buffer_load_dwordx4 a[216:219], v1, s[32:35], s69 offen offset:2048 sc1
    v_exp_f32 v18, v18
    v_exp_f32 v19, v19
    v_cvt_pk_bf16_f32 v48, v16, v17
    v_exp_f32 v20, v20
    v_exp_f32 v21, v21
    v_cvt_pk_bf16_f32 v49, v18, v19
    v_mfma_f32_32x32x16_bf16 v[32:47], a[52:55], a[124:127], v[32:47]
    s_add_u32 m0, s45, 3712
    s_nop 0
    buffer_load_dwordx4 v7, s[24:27], s64 offen offset:0 lds
    v_exp_f32 v22, v22
    v_exp_f32 v23, v23
    v_cvt_pk_bf16_f32 v50, v20, v21
    v_exp_f32 v24, v24
    v_exp_f32_e64 v25, v25
    v_cvt_pk_bf16_f32 v51, v22, v23
WPAD41:
    s_cbranch_execz WRET0
    v_mfma_f32_32x32x16_bf16 a[144:159], a[56:59], v[56:59], a[144:159]
    buffer_load_dwordx4 v6, s[24:27], s64 offen offset:896 lds
    v_exp_f32 v26, v26
    v_exp_f32 v27, v27
    v_cvt_pk_bf16_f32 v52, v24, v25
    v_exp_f32 v28, v28
    v_exp_f32 v29, v29
    v_cvt_pk_bf16_f32 v53, v26, v27
    v_mfma_f32_32x32x16_bf16 a[144:159], a[60:63], v[60:63], a[144:159]
    s_waitcnt vmcnt(31)
    v_exp_f32 v30, v30
    v_exp_f32 v31, v31
    v_cvt_pk_bf16_f32 v54, v28, v29
    v_exp_f32 v32, v32
    v_exp_f32 v33, v33
    v_cvt_pk_bf16_f32 v55, v30, v31
    v_mfma_f32_32x32x16_bf16 v[16:31], a[64:67], a[96:99], 0
    s_waitcnt vmcnt(30)
    buffer_load_dwordx4 a[220:223], v1, s[32:35], s69 offen offset:3072 sc1
    s_add_u32 s69, s69, 4096
    v_exp_f32 v34, v34
    v_exp_f32 v35, v35
    v_cvt_pk_bf16_f32 v56, v32, v33
    v_exp_f32 v36, v36
    v_exp_f32 v37, v37
    v_cvt_pk_bf16_f32 v57, v34, v35
    v_mfma_f32_32x32x16_bf16 v[16:31], a[68:71], a[100:103], v[16:31]
    buffer_load_dwordx4 v13, s[24:27], s64 offen offset:1792 lds
    v_exp_f32 v38, v38
    v_exp_f32 v39, v39
    v_cvt_pk_bf16_f32 v58, v36, v37
    v_exp_f32 v40, v40
    v_exp_f32 v41, v41
    v_cvt_pk_bf16_f32 v59, v38, v39
    v_mfma_f32_32x32x16_bf16 a[160:175], a[56:59], v[48:51], a[160:175]
    v_exp_f32 v42, v42
    v_exp_f32 v43, v43
    v_cvt_pk_bf16_f32 v60, v40, v41
    v_exp_f32 v44, v44
    v_exp_f32 v45, v45
    v_cvt_pk_bf16_f32 v61, v42, v43
    v_mfma_f32_32x32x16_bf16 a[160:175], a[60:63], v[52:55], a[160:175]
    v_exp_f32 v46, v46
    v_exp_f32 v47, v47
    v_cvt_pk_bf16_f32 v62, v44, v45
    v_exp_f32 v16, v16
    v_exp_f32 v17, v17
    v_cvt_pk_bf16_f32 v63, v46, v47
    v_mfma_f32_32x32x16_bf16 v[32:47], a[64:67], a[104:107], 0
    buffer_load_dwordx4 a[224:227], v1, s[32:35], s69 offen offset:0 sc1
    v_exp_f32 v18, v18
    v_exp_f32 v19, v19
    v_cvt_pk_bf16_f32 v48, v16, v17
    v_exp_f32 v20, v20
    v_exp_f32 v21, v21
    v_cvt_pk_bf16_f32 v49, v18, v19
    v_mfma_f32_32x32x16_bf16 v[32:47], a[68:71], a[108:111], v[32:47]
    buffer_load_dwordx4 v8, s[24:27], s64 offen offset:2688 lds
    s_add_u32 s64, s64, 57344
    v_exp_f32 v22, v22
    v_exp_f32 v23, v23
    v_cvt_pk_bf16_f32 v50, v20, v21
    v_exp_f32 v24, v24
    v_exp_f32 v25, v25
    v_cvt_pk_bf16_f32 v51, v22, v23
    v_mfma_f32_32x32x16_bf16 v[64:79], a[56:59], v[56:59], v[64:79]
    v_exp_f32 v26, v26
    v_exp_f32 v27, v27
    v_cvt_pk_bf16_f32 v52, v24, v25
    v_exp_f32 v28, v28
    v_exp_f32 v29, v29
    v_cvt_pk_bf16_f32 v53, v26, v27
    v_mfma_f32_32x32x16_bf16 v[64:79], a[60:63], v[60:63], v[64:79]
    v_exp_f32 v30, v30
    v_exp_f32 v31, v31
    v_cvt_pk_bf16_f32 v54, v28, v29
    v_exp_f32 v32, v32
    v_exp_f32 v33, v33
    v_cvt_pk_bf16_f32 v55, v30, v31
    v_mfma_f32_32x32x16_bf16 v[16:31], a[64:67], a[112:115], 0
    buffer_load_dwordx4 a[228:231], v1, s[32:35], s69 offen offset:1024 sc1
    v_exp_f32 v34, v34
    v_exp_f32 v35, v35
    v_cvt_pk_bf16_f32 v56, v32, v33
    v_exp_f32 v36, v36
    v_exp_f32_e64 v37, v37
WPAD42:
    s_cbranch_execz WRET0
    v_cvt_pk_bf16_f32 v57, v34, v35
    v_mfma_f32_32x32x16_bf16 v[16:31], a[68:71], a[116:119], v[16:31]
    s_waitcnt vmcnt(34)
    s_add_u32 m0, s45, 7424
    s_nop 0
    buffer_load_dwordx4 v7, s[24:27], s64 offen offset:0 lds
    v_exp_f32 v38, v38
    v_exp_f32 v39, v39
    v_cvt_pk_bf16_f32 v58, v36, v37
    v_exp_f32 v40, v40
    v_exp_f32 v41, v41
    v_cvt_pk_bf16_f32 v59, v38, v39
    v_mfma_f32_32x32x16_bf16 a[128:143], a[72:75], v[48:51], a[128:143]
    s_waitcnt vmcnt(34)
    buffer_load_dwordx4 v6, s[24:27], s64 offen offset:896 lds
    v_exp_f32 v42, v42
    v_exp_f32 v43, v43
    v_cvt_pk_bf16_f32 v60, v40, v41
    v_exp_f32 v44, v44
    v_exp_f32 v45, v45
    v_cvt_pk_bf16_f32 v61, v42, v43
    v_mfma_f32_32x32x16_bf16 a[128:143], a[76:79], v[52:55], a[128:143]
    v_exp_f32 v46, v46
    v_exp_f32 v47, v47
    v_cvt_pk_bf16_f32 v62, v44, v45
    v_exp_f32 v16, v16
    v_exp_f32 v17, v17
    v_cvt_pk_bf16_f32 v63, v46, v47
    v_mfma_f32_32x32x16_bf16 v[32:47], a[64:67], a[120:123], 0
    buffer_load_dwordx4 a[232:235], v1, s[32:35], s69 offen offset:2048 sc1
    v_exp_f32 v18, v18
    v_exp_f32 v19, v19
    v_cvt_pk_bf16_f32 v48, v16, v17
    v_exp_f32 v20, v20
    v_exp_f32 v21, v21
    v_cvt_pk_bf16_f32 v49, v18, v19
    v_mfma_f32_32x32x16_bf16 v[32:47], a[68:71], a[124:127], v[32:47]
    buffer_load_dwordx4 v13, s[24:27], s64 offen offset:1792 lds
    v_exp_f32 v22, v22
    v_exp_f32 v23, v23
    v_cvt_pk_bf16_f32 v50, v20, v21
    v_exp_f32 v24, v24
    v_exp_f32 v25, v25
    v_cvt_pk_bf16_f32 v51, v22, v23
    v_mfma_f32_32x32x16_bf16 a[144:159], a[72:75], v[56:59], a[144:159]
    v_exp_f32 v26, v26
    v_exp_f32 v27, v27
    v_cvt_pk_bf16_f32 v52, v24, v25
    v_exp_f32 v28, v28
    v_exp_f32 v29, v29
    v_cvt_pk_bf16_f32 v53, v26, v27
    v_mfma_f32_32x32x16_bf16 a[144:159], a[76:79], v[60:63], a[144:159]
    s_waitcnt vmcnt(36)
    v_exp_f32 v30, v30
    v_exp_f32 v31, v31
    v_cvt_pk_bf16_f32 v54, v28, v29
    v_exp_f32 v32, v32
    v_exp_f32 v33, v33
    v_cvt_pk_bf16_f32 v55, v30, v31
    v_mfma_f32_32x32x16_bf16 v[16:31], a[80:83], a[96:99], 0
    s_waitcnt vmcnt(35)
    buffer_load_dwordx4 a[236:239], v1, s[32:35], s69 offen offset:3072 sc1
    s_add_u32 s69, s69, 4096
    v_exp_f32 v34, v34
    v_exp_f32 v35, v35
    v_cvt_pk_bf16_f32 v56, v32, v33
    v_exp_f32 v36, v36
    v_exp_f32 v37, v37
    v_cvt_pk_bf16_f32 v57, v34, v35
    v_mfma_f32_32x32x16_bf16 v[16:31], a[84:87], a[100:103], v[16:31]
    buffer_load_dwordx4 v8, s[24:27], s64 offen offset:2688 lds
    s_add_u32 s64, s64, 57344
    v_exp_f32 v38, v38
    v_exp_f32 v39, v39
    v_cvt_pk_bf16_f32 v58, v36, v37
    v_exp_f32 v40, v40
    v_exp_f32 v41, v41
    v_cvt_pk_bf16_f32 v59, v38, v39
    v_mfma_f32_32x32x16_bf16 a[160:175], a[72:75], v[48:51], a[160:175]
    v_exp_f32 v42, v42
    v_exp_f32 v43, v43
    v_cvt_pk_bf16_f32 v60, v40, v41
    v_exp_f32 v44, v44
    v_exp_f32 v45, v45
    v_cvt_pk_bf16_f32 v61, v42, v43
    v_mfma_f32_32x32x16_bf16 a[160:175], a[76:79], v[52:55], a[160:175]
WPAD43:
    s_cbranch_execz WRET0
    v_exp_f32 v46, v46
    v_exp_f32 v47, v47
    v_cvt_pk_bf16_f32 v62, v44, v45
    v_exp_f32 v16, v16
    v_exp_f32 v17, v17
    v_cvt_pk_bf16_f32 v63, v46, v47
    v_mfma_f32_32x32x16_bf16 v[32:47], a[80:83], a[104:107], 0
    s_waitcnt vmcnt(28)
    buffer_store_dword v12, v11, s[32:35], s72 offen sc1
    v_exp_f32 v18, v18
    v_exp_f32 v19, v19
    v_cvt_pk_bf16_f32 v48, v16, v17
    v_exp_f32 v20, v20
    v_exp_f32 v21, v21
    v_cvt_pk_bf16_f32 v49, v18, v19
    v_mfma_f32_32x32x16_bf16 v[32:47], a[84:87], a[108:111], v[32:47]
    buffer_load_dwordx4 a[32:35], v1, s[32:35], s69 offen offset:0 sc1
    s_add_u32 m0, s45, 11136
    v_exp_f32 v22, v22
    v_exp_f32 v23, v23
    v_cvt_pk_bf16_f32 v50, v20, v21
    v_exp_f32 v24, v24
    v_exp_f32 v25, v25
    v_cvt_pk_bf16_f32 v51, v22, v23
    v_mfma_f32_32x32x16_bf16 v[64:79], a[72:75], v[56:59], v[64:79]
    buffer_load_dwordx4 v7, s[24:27], s64 offen offset:0 lds
    buffer_load_dwordx4 v6, s[24:27], s64 offen offset:896 lds
    v_exp_f32 v26, v26
    v_exp_f32 v27, v27
    v_cvt_pk_bf16_f32 v52, v24, v25
    v_exp_f32 v28, v28
    v_exp_f32 v29, v29
    v_cvt_pk_bf16_f32 v53, v26, v27
    v_mfma_f32_32x32x16_bf16 v[64:79], a[76:79], v[60:63], v[64:79]
    v_exp_f32 v30, v30
    v_exp_f32 v31, v31
    v_cvt_pk_bf16_f32 v54, v28, v29
    v_exp_f32 v32, v32
    v_exp_f32 v33, v33
    v_cvt_pk_bf16_f32 v55, v30, v31
    v_mfma_f32_32x32x16_bf16 v[16:31], a[80:83], a[112:115], 0
    buffer_load_dwordx4 a[36:39], v1, s[32:35], s69 offen offset:1024 sc1
    v_exp_f32 v34, v34
    v_exp_f32 v35, v35
    v_cvt_pk_bf16_f32 v56, v32, v33
    v_exp_f32 v36, v36
    v_exp_f32 v37, v37
    v_cvt_pk_bf16_f32 v57, v34, v35
    v_mfma_f32_32x32x16_bf16 v[16:31], a[84:87], a[116:119], v[16:31]
    buffer_load_dwordx4 v13, s[24:27], s64 offen offset:1792 lds
    v_exp_f32 v38, v38
    v_exp_f32 v39, v39
    v_cvt_pk_bf16_f32 v58, v36, v37
    v_exp_f32 v40, v40
    v_exp_f32 v41, v41
    v_cvt_pk_bf16_f32 v59, v38, v39
    v_mfma_f32_32x32x16_bf16 a[128:143], a[88:91], v[48:51], a[128:143]
    v_exp_f32 v42, v42
    v_exp_f32 v43, v43
    v_cvt_pk_bf16_f32 v60, v40, v41
    v_exp_f32 v44, v44
    v_exp_f32 v45, v45
    v_cvt_pk_bf16_f32 v61, v42, v43
    v_mfma_f32_32x32x16_bf16 a[128:143], a[92:95], v[52:55], a[128:143]
    v_exp_f32 v46, v46
    v_exp_f32 v47, v47
    v_cvt_pk_bf16_f32 v62, v44, v45
    v_exp_f32 v16, v16
    v_exp_f32 v17, v17
    v_cvt_pk_bf16_f32 v63, v46, v47
    v_mfma_f32_32x32x16_bf16 v[32:47], a[80:83], a[120:123], 0
    buffer_load_dwordx4 a[40:43], v1, s[32:35], s69 offen offset:2048 sc1
    v_exp_f32 v18, v18
    v_exp_f32 v19, v19
    v_cvt_pk_bf16_f32 v48, v16, v17
    v_exp_f32 v20, v20
    v_exp_f32 v21, v21
    v_cvt_pk_bf16_f32 v49, v18, v19
    v_mfma_f32_32x32x16_bf16 v[32:47], a[84:87], a[124:127], v[32:47]
    buffer_load_dwordx4 v8, s[24:27], s64 offen offset:2688 lds
    s_add_u32 s64, s64, 57344
    v_exp_f32 v22, v22
    v_exp_f32 v23, v23
    v_cvt_pk_bf16_f32 v50, v20, v21
    v_exp_f32 v24, v24
    v_exp_f32 v25, v25
WPAD44:
    s_cbranch_execz WRET0
    v_cvt_pk_bf16_f32 v51, v22, v23
    v_mfma_f32_32x32x16_bf16 a[144:159], a[88:91], v[56:59], a[144:159]
    v_exp_f32 v26, v26
    v_exp_f32 v27, v27
    v_cvt_pk_bf16_f32 v52, v24, v25
    v_exp_f32 v28, v28
    v_exp_f32 v29, v29
    v_cvt_pk_bf16_f32 v53, v26, v27
    v_mfma_f32_32x32x16_bf16 a[144:159], a[92:95], v[60:63], a[144:159]
    s_waitcnt vmcnt(35)
    v_exp_f32 v30, v30
    v_exp_f32 v31, v31
    v_cvt_pk_bf16_f32 v54, v28, v29
    v_exp_f32 v32, v32
    v_exp_f32 v33, v33
    v_cvt_pk_bf16_f32 v55, v30, v31
    v_mfma_f32_32x32x16_bf16 v[16:31], a[192:195], a[96:99], 0
    s_waitcnt vmcnt(32)
    buffer_load_dwordx4 a[44:47], v1, s[32:35], s69 offen offset:3072 sc1
    s_add_u32 s69, s69, 4096
    v_exp_f32 v34, v34
    v_exp_f32 v35, v35
    v_cvt_pk_bf16_f32 v56, v32, v33
    v_exp_f32 v36, v36
    v_exp_f32 v37, v37
    v_cvt_pk_bf16_f32 v57, v34, v35
    v_mfma_f32_32x32x16_bf16 v[16:31], a[196:199], a[100:103], v[16:31]
    s_add_u32 m0, s45, 14848
    s_nop 0
    buffer_load_dwordx4 v7, s[24:27], s64 offen offset:0 lds
    v_exp_f32 v38, v38
    v_exp_f32 v39, v39
    v_cvt_pk_bf16_f32 v58, v36, v37
    v_exp_f32 v40, v40
    v_exp_f32 v41, v41
    v_cvt_pk_bf16_f32 v59, v38, v39
    v_mfma_f32_32x32x16_bf16 a[160:175], a[88:91], v[48:51], a[160:175]
    buffer_load_dwordx4 v6, s[24:27], s64 offen offset:896 lds
    v_exp_f32 v42, v42
    v_exp_f32 v43, v43
    v_cvt_pk_bf16_f32 v60, v40, v41
    v_exp_f32 v44, v44
    v_exp_f32 v45, v45
    v_cvt_pk_bf16_f32 v61, v42, v43
    v_mfma_f32_32x32x16_bf16 a[160:175], a[92:95], v[52:55], a[160:175]
    v_exp_f32 v46, v46
    v_exp_f32 v47, v47
    v_cvt_pk_bf16_f32 v62, v44, v45
    v_exp_f32 v16, v16
    v_exp_f32 v17, v17
    v_cvt_pk_bf16_f32 v63, v46, v47
    v_mfma_f32_32x32x16_bf16 v[32:47], a[192:195], a[104:107], 0
    buffer_load_dwordx4 a[48:51], v1, s[32:35], s69 offen offset:0 sc1
    v_exp_f32 v18, v18
    v_exp_f32 v19, v19
    v_cvt_pk_bf16_f32 v48, v16, v17
    v_exp_f32 v20, v20
    v_exp_f32 v21, v21
    v_cvt_pk_bf16_f32 v49, v18, v19
    v_mfma_f32_32x32x16_bf16 v[32:47], a[196:199], a[108:111], v[32:47]
    buffer_load_dwordx4 v13, s[24:27], s64 offen offset:1792 lds
    v_exp_f32 v22, v22
    v_exp_f32 v23, v23
    v_cvt_pk_bf16_f32 v50, v20, v21
    v_exp_f32 v24, v24
    v_exp_f32 v25, v25
    v_cvt_pk_bf16_f32 v51, v22, v23
    v_mfma_f32_32x32x16_bf16 v[64:79], a[88:91], v[56:59], v[64:79]
    v_exp_f32 v26, v26
    v_exp_f32 v27, v27
    v_cvt_pk_bf16_f32 v52, v24, v25
    v_exp_f32 v28, v28
    v_exp_f32 v29, v29
    v_cvt_pk_bf16_f32 v53, v26, v27
    v_mfma_f32_32x32x16_bf16 v[64:79], a[92:95], v[60:63], v[64:79]
    v_exp_f32 v30, v30
    v_exp_f32 v31, v31
    v_cvt_pk_bf16_f32 v54, v28, v29
    v_exp_f32 v32, v32
    v_exp_f32 v33, v33
    v_cvt_pk_bf16_f32 v55, v30, v31
    v_mfma_f32_32x32x16_bf16 v[16:31], a[192:195], a[112:115], 0
    buffer_load_dwordx4 a[52:55], v1, s[32:35], s69 offen offset:1024 sc1
    v_exp_f32 v34, v34
    v_exp_f32 v35, v35
    v_cvt_pk_bf16_f32 v56, v32, v33
WPAD45:
    s_cbranch_execz WRET0
    v_exp_f32 v36, v36
    v_exp_f32 v37, v37
    v_cvt_pk_bf16_f32 v57, v34, v35
    v_mfma_f32_32x32x16_bf16 v[16:31], a[196:199], a[116:119], v[16:31]
    s_waitcnt vmcnt(36)
    buffer_load_dwordx4 v8, s[24:27], s64 offen offset:2688 lds
    s_add_u32 s64, s64, 57344
    v_exp_f32 v38, v38
    v_exp_f32 v39, v39
    v_cvt_pk_bf16_f32 v58, v36, v37
    v_exp_f32 v40, v40
    v_exp_f32 v41, v41
    v_cvt_pk_bf16_f32 v59, v38, v39
    v_mfma_f32_32x32x16_bf16 a[128:143], a[200:203], v[48:51], a[128:143]
    s_waitcnt vmcnt(35)
    v_exp_f32 v42, v42
    v_exp_f32 v43, v43
    v_cvt_pk_bf16_f32 v60, v40, v41
    v_exp_f32 v44, v44
    v_exp_f32 v45, v45
    v_cvt_pk_bf16_f32 v61, v42, v43
    v_mfma_f32_32x32x16_bf16 a[128:143], a[204:207], v[52:55], a[128:143]
    v_exp_f32 v46, v46
    v_exp_f32 v47, v47
    v_cvt_pk_bf16_f32 v62, v44, v45
    v_exp_f32 v16, v16
    v_exp_f32 v17, v17
    v_cvt_pk_bf16_f32 v63, v46, v47
    v_mfma_f32_32x32x16_bf16 v[32:47], a[192:195], a[120:123], 0
    buffer_load_dwordx4 a[56:59], v1, s[32:35], s69 offen offset:2048 sc1
    v_exp_f32 v18, v18
    v_exp_f32 v19, v19
    v_cvt_pk_bf16_f32 v48, v16, v17
    v_exp_f32 v20, v20
    v_exp_f32 v21, v21
    v_cvt_pk_bf16_f32 v49, v18, v19
    v_mfma_f32_32x32x16_bf16 v[32:47], a[196:199], a[124:127], v[32:47]
    s_add_u32 m0, s45, 18560
    s_nop 0
    buffer_load_dwordx4 v7, s[24:27], s64 offen offset:0 lds
    v_exp_f32 v22, v22
    v_exp_f32 v23, v23
    v_cvt_pk_bf16_f32 v50, v20, v21
    v_exp_f32 v24, v24
    v_exp_f32 v25, v25
    v_cvt_pk_bf16_f32 v51, v22, v23
    v_mfma_f32_32x32x16_bf16 a[144:159], a[200:203], v[56:59], a[144:159]
    buffer_load_dwordx4 v6, s[24:27], s64 offen offset:896 lds
    v_exp_f32 v26, v26
    v_exp_f32 v27, v27
    v_cvt_pk_bf16_f32 v52, v24, v25
    v_exp_f32 v28, v28
    v_exp_f32 v29, v29
    v_cvt_pk_bf16_f32 v53, v26, v27
    v_mfma_f32_32x32x16_bf16 a[144:159], a[204:207], v[60:63], a[144:159]
    s_waitcnt vmcnt(35)
    v_exp_f32 v30, v30
    v_exp_f32 v31, v31
    v_cvt_pk_bf16_f32 v54, v28, v29
    v_exp_f32 v32, v32
    v_exp_f32 v33, v33
    v_cvt_pk_bf16_f32 v55, v30, v31
    v_mfma_f32_32x32x16_bf16 v[16:31], a[208:211], a[96:99], 0
    s_waitcnt vmcnt(33)
    buffer_load_dword v245, v9, s[32:35], s73 offen sc1
    buffer_load_dwordx4 a[60:63], v1, s[32:35], s69 offen offset:3072 sc1
    v_exp_f32 v34, v34
    v_exp_f32 v35, v35
    v_cvt_pk_bf16_f32 v56, v32, v33
    v_exp_f32 v36, v36
    v_exp_f32 v37, v37
    v_cvt_pk_bf16_f32 v57, v34, v35
    v_mfma_f32_32x32x16_bf16 v[16:31], a[212:215], a[100:103], v[16:31]
    s_add_u32 s69, s69, 4096
    buffer_load_dwordx4 v13, s[24:27], s64 offen offset:1792 lds
    v_exp_f32 v38, v38
    v_exp_f32 v39, v39
    v_cvt_pk_bf16_f32 v58, v36, v37
    v_exp_f32 v40, v40
    v_exp_f32 v41, v41
    v_cvt_pk_bf16_f32 v59, v38, v39
    v_mfma_f32_32x32x16_bf16 a[160:175], a[200:203], v[48:51], a[160:175]
    v_exp_f32 v42, v42
    v_exp_f32 v43, v43
    v_cvt_pk_bf16_f32 v60, v40, v41
    v_exp_f32 v44, v44
    v_exp_f32 v45, v45
WPAD46:
    s_cbranch_execz WRET0
    v_cvt_pk_bf16_f32 v61, v42, v43
    v_mfma_f32_32x32x16_bf16 a[160:175], a[204:207], v[52:55], a[160:175]
    v_exp_f32 v46, v46
    v_exp_f32 v47, v47
    v_cvt_pk_bf16_f32 v62, v44, v45
    v_exp_f32 v16, v16
    v_exp_f32 v17, v17
    v_cvt_pk_bf16_f32 v63, v46, v47
    v_mfma_f32_32x32x16_bf16 v[32:47], a[208:211], a[104:107], 0
    buffer_load_dwordx4 a[64:67], v1, s[32:35], s69 offen offset:0 sc1
    v_exp_f32 v18, v18
    v_exp_f32 v19, v19
    v_cvt_pk_bf16_f32 v48, v16, v17
    v_exp_f32 v20, v20
    v_exp_f32 v21, v21
    v_cvt_pk_bf16_f32 v49, v18, v19
    v_mfma_f32_32x32x16_bf16 v[32:47], a[212:215], a[108:111], v[32:47]
    buffer_load_dwordx4 v8, s[24:27], s64 offen offset:2688 lds
    v_exp_f32 v22, v22
    v_exp_f32 v23, v23
    v_cvt_pk_bf16_f32 v50, v20, v21
    v_exp_f32 v24, v24
    v_exp_f32 v25, v25
    v_cvt_pk_bf16_f32 v51, v22, v23
    v_mfma_f32_32x32x16_bf16 v[64:79], a[200:203], v[56:59], v[64:79]
    v_exp_f32 v26, v26
    v_exp_f32 v27, v27
    v_cvt_pk_bf16_f32 v52, v24, v25
    v_exp_f32 v28, v28
    v_exp_f32 v29, v29
    v_cvt_pk_bf16_f32 v53, v26, v27
    v_mfma_f32_32x32x16_bf16 v[64:79], a[204:207], v[60:63], v[64:79]
    v_exp_f32 v30, v30
    v_exp_f32 v31, v31
    v_cvt_pk_bf16_f32 v54, v28, v29
    v_exp_f32 v32, v32
    v_exp_f32 v33, v33
    v_cvt_pk_bf16_f32 v55, v30, v31
    v_mfma_f32_32x32x16_bf16 v[16:31], a[208:211], a[112:115], 0
    buffer_load_dwordx4 a[68:71], v1, s[32:35], s69 offen offset:1024 sc1
    v_exp_f32 v34, v34
    v_exp_f32 v35, v35
    v_cvt_pk_bf16_f32 v56, v32, v33
    v_exp_f32 v36, v36
    v_exp_f32 v37, v37
    v_cvt_pk_bf16_f32 v57, v34, v35
    v_mfma_f32_32x32x16_bf16 v[16:31], a[212:215], a[116:119], v[16:31]
    s_waitcnt vmcnt(37)
    v_exp_f32 v38, v38
    v_exp_f32 v39, v39
    v_cvt_pk_bf16_f32 v58, v36, v37
    v_exp_f32 v40, v40
    v_exp_f32 v41, v41
    v_cvt_pk_bf16_f32 v59, v38, v39
    v_mfma_f32_32x32x16_bf16 a[128:143], a[216:219], v[48:51], a[128:143]
    s_waitcnt vmcnt(34)
    v_exp_f32 v42, v42
    v_exp_f32 v43, v43
    v_cvt_pk_bf16_f32 v60, v40, v41
    v_exp_f32 v44, v44
    v_exp_f32 v45, v45
    v_cvt_pk_bf16_f32 v61, v42, v43
    v_mfma_f32_32x32x16_bf16 a[128:143], a[220:223], v[52:55], a[128:143]
    v_exp_f32 v46, v46
    v_exp_f32 v47, v47
    v_cvt_pk_bf16_f32 v62, v44, v45
    v_exp_f32 v16, v16
    v_exp_f32 v17, v17
    v_cvt_pk_bf16_f32 v63, v46, v47
    v_mfma_f32_32x32x16_bf16 v[32:47], a[208:211], a[120:123], 0
    s_waitcnt vmcnt(5)
    v_cmp_ne_u32 vcc, s46, v245
    s_cbranch_vccnz SPIN_H
RET_H:
    buffer_load_dwordx4 a[72:75], v1, s[32:35], s69 offen offset:2048 sc1
    buffer_load_dwordx4 v[80:83], v1, s[32:35], s74 offen offset:0 sc1
    v_exp_f32 v18, v18
    v_exp_f32 v19, v19
    v_cvt_pk_bf16_f32 v48, v16, v17
    v_exp_f32 v20, v20
    v_exp_f32 v21, v21
    v_cvt_pk_bf16_f32 v49, v18, v19
    v_mfma_f32_32x32x16_bf16 v[32:47], a[212:215], a[124:127], v[32:47]
    buffer_load_dwordx4 v[84:87], v1, s[32:35], s74 offen offset:1024 sc1
    buffer_load_dwordx4 v[88:91], v1, s[32:35], s74 offen offset:2048 sc1
    v_exp_f32 v22, v22
    v_exp_f32 v23, v23
    v_cvt_pk_bf16_f32 v50, v20, v21
WPAD47:
    s_cbranch_execz WRET0
    v_exp_f32 v24, v24
    v_exp_f32 v25, v25
    v_cvt_pk_bf16_f32 v51, v22, v23
    v_mfma_f32_32x32x16_bf16 a[144:159], a[216:219], v[56:59], a[144:159]
    buffer_load_dwordx4 v[92:95], v1, s[32:35], s74 offen offset:3072 sc1
    s_add_u32 s74, s74, 4096
    v_exp_f32 v26, v26
    v_exp_f32 v27, v27
    v_cvt_pk_bf16_f32 v52, v24, v25
    v_exp_f32 v28, v28
    v_exp_f32 v29, v29
    v_cvt_pk_bf16_f32 v53, v26, v27
    v_mfma_f32_32x32x16_bf16 a[144:159], a[220:223], v[60:63], a[144:159]
    buffer_load_dwordx4 v[96:99], v1, s[32:35], s74 offen offset:0 sc1
    buffer_load_dwordx4 v[100:103], v1, s[32:35], s74 offen offset:1024 sc1
    v_exp_f32 v30, v30
    v_exp_f32 v31, v31
    v_cvt_pk_bf16_f32 v54, v28, v29
    v_exp_f32 v32, v32
    v_exp_f32 v33, v33
    v_cvt_pk_bf16_f32 v55, v30, v31
    v_mfma_f32_32x32x16_bf16 v[16:31], a[224:227], a[96:99], 0
    buffer_load_dwordx4 v[104:107], v1, s[32:35], s74 offen offset:2048 sc1
    buffer_load_dwordx4 v[108:111], v1, s[32:35], s74 offen offset:3072 sc1
    v_exp_f32 v34, v34
    v_exp_f32 v35, v35
    v_cvt_pk_bf16_f32 v56, v32, v33
    v_exp_f32 v36, v36
    v_exp_f32 v37, v37
    v_cvt_pk_bf16_f32 v57, v34, v35
    v_mfma_f32_32x32x16_bf16 v[16:31], a[228:231], a[100:103], v[16:31]
    s_add_u32 s74, s74, 4096
    buffer_load_dwordx4 v[112:115], v1, s[32:35], s74 offen offset:0 sc1
    v_exp_f32 v38, v38
    v_exp_f32 v39, v39
    v_cvt_pk_bf16_f32 v58, v36, v37
    v_exp_f32 v40, v40
    v_exp_f32 v41, v41
    v_cvt_pk_bf16_f32 v59, v38, v39
    v_mfma_f32_32x32x16_bf16 a[160:175], a[216:219], v[48:51], a[160:175]
    buffer_load_dwordx4 v[116:119], v1, s[32:35], s74 offen offset:1024 sc1
    buffer_load_dwordx4 v[120:123], v1, s[32:35], s74 offen offset:2048 sc1
    v_exp_f32 v42, v42
    v_exp_f32 v43, v43
    v_cvt_pk_bf16_f32 v60, v40, v41
    v_exp_f32 v44, v44
    v_exp_f32 v45, v45
    v_cvt_pk_bf16_f32 v61, v42, v43
    v_mfma_f32_32x32x16_bf16 a[160:175], a[220:223], v[52:55], a[160:175]
    buffer_load_dwordx4 v[124:127], v1, s[32:35], s74 offen offset:3072 sc1
    buffer_load_dwordx4 a[76:79], v1, s[32:35], s69 offen offset:3072 sc1
    v_exp_f32 v46, v46
    v_exp_f32 v47, v47
    v_cvt_pk_bf16_f32 v62, v44, v45
    v_exp_f32 v16, v16
    v_exp_f32 v17, v17
    v_cvt_pk_bf16_f32 v63, v46, v47
    v_mfma_f32_32x32x16_bf16 v[32:47], a[224:227], a[104:107], 0
    s_add_u32 s69, s69, 4096
    buffer_load_dwordx4 a[80:83], v1, s[32:35], s69 offen offset:0 sc1
    v_exp_f32 v18, v18
    v_exp_f32 v19, v19
    v_cvt_pk_bf16_f32 v48, v16, v17
    v_exp_f32 v20, v20
    v_exp_f32 v21, v21
    v_cvt_pk_bf16_f32 v49, v18, v19
    v_mfma_f32_32x32x16_bf16 v[32:47], a[228:231], a[108:111], v[32:47]
    buffer_load_dwordx4 a[84:87], v1, s[32:35], s69 offen offset:1024 sc1
    s_add_u32 s74, s74, 4096
    v_exp_f32 v22, v22
    v_exp_f32 v23, v23
    v_cvt_pk_bf16_f32 v50, v20, v21
    v_exp_f32 v24, v24
    v_exp_f32 v25, v25
    v_cvt_pk_bf16_f32 v51, v22, v23
    v_mfma_f32_32x32x16_bf16 v[64:79], a[216:219], v[56:59], v[64:79]
    v_exp_f32 v26, v26
    v_exp_f32 v27, v27
    v_cvt_pk_bf16_f32 v52, v24, v25
    v_exp_f32 v28, v28
    v_exp_f32_e64 v29, v29
    v_cvt_pk_bf16_f32 v53, v26, v27
WPAD48:
    s_cbranch_execz WRET0
    v_mfma_f32_32x32x16_bf16 v[64:79], a[220:223], v[60:63], v[64:79]
    v_exp_f32 v30, v30
    v_exp_f32 v31, v31
    v_cvt_pk_bf16_f32 v54, v28, v29
    v_exp_f32 v32, v32
    v_exp_f32 v33, v33
    v_cvt_pk_bf16_f32 v55, v30, v31
    v_mfma_f32_32x32x16_bf16 v[16:31], a[224:227], a[112:115], 0
    s_barrier
    ds_read_b64_tr_b16 v[208:209], v5 offset:33408
    ds_read_b64_tr_b16 v[210:211], v5 offset:33856
    ds_read_b64_tr_b16 v[212:213], v5 offset:33464
    buffer_load_dwordx4 a[88:91], v1, s[32:35], s69 offen offset:2048 sc1
    buffer_load_dwordx4 a[92:95], v1, s[32:35], s69 offen offset:3072 sc1
    v_exp_f32 v34, v34
    v_exp_f32 v35, v35
    v_cvt_pk_bf16_f32 v56, v32, v33
    v_exp_f32 v36, v36
    v_exp_f32 v37, v37
    v_cvt_pk_bf16_f32 v57, v34, v35
    v_mfma_f32_32x32x16_bf16 v[16:31], a[228:231], a[116:119], v[16:31]
    ds_read_b64_tr_b16 v[214:215], v5 offset:33912
    ds_read_b64_tr_b16 v[216:217], v5 offset:33520
    ds_read_b64_tr_b16 v[218:219], v5 offset:33968
    s_add_u32 s69, s69, 4096
    v_exp_f32 v38, v38
    v_exp_f32 v39, v39
    v_cvt_pk_bf16_f32 v58, v36, v37
    v_exp_f32 v40, v40
    v_exp_f32 v41, v41
    v_cvt_pk_bf16_f32 v59, v38, v39
    v_mfma_f32_32x32x16_bf16 a[128:143], a[232:235], v[48:51], a[128:143]
    ds_read_b64_tr_b16 v[220:221], v5 offset:33576
    ds_read_b64_tr_b16 v[222:223], v5 offset:34024
    v_exp_f32 v42, v42
    v_exp_f32 v43, v43
    v_cvt_pk_bf16_f32 v60, v40, v41
    v_exp_f32 v44, v44
    v_exp_f32 v45, v45
    v_cvt_pk_bf16_f32 v61, v42, v43
    v_mfma_f32_32x32x16_bf16 a[128:143], a[236:239], v[52:55], a[128:143]
    s_waitcnt vmcnt(16) lgkmcnt(6)
    v_exp_f32 v46, v46
    v_exp_f32 v47, v47
    v_cvt_pk_bf16_f32 v62, v44, v45
    v_mfma_f32_32x32x16_bf16 v[128:143], v[208:211], v[80:83], 0
    ds_read_b64_tr_b16 v[224:225], v5 offset:34304
    ds_read_b64_tr_b16 v[226:227], v5 offset:34752
    buffer_load_dwordx4 a[192:195], v1, s[32:35], s69 offen offset:0 sc1
    v_exp_f32 v16, v16
    v_exp_f32 v17, v17
    v_cvt_pk_bf16_f32 v63, v46, v47
    v_mfma_f32_32x32x16_bf16 v[32:47], a[224:227], a[120:123], 0
    s_waitcnt lgkmcnt(6)
    ds_read_b64_tr_b16 v[228:229], v5 offset:34360
    ds_read_b64_tr_b16 v[230:231], v5 offset:34808
    v_mfma_f32_32x32x16_bf16 v[144:159], v[212:215], v[80:83], 0
    ds_read_b64_tr_b16 v[232:233], v5 offset:34416
    ds_read_b64_tr_b16 v[234:235], v5 offset:34864
    v_exp_f32 v18, v18
    v_exp_f32 v19, v19
    v_cvt_pk_bf16_f32 v48, v16, v17
    v_mfma_f32_32x32x16_bf16 v[32:47], a[228:231], a[124:127], v[32:47]
    s_waitcnt lgkmcnt(8)
    ds_read_b64_tr_b16 v[236:237], v5 offset:34472
    v_exp_f32 v20, v20
    v_exp_f32 v21, v21
    v_cvt_pk_bf16_f32 v49, v18, v19
    v_mfma_f32_32x32x16_bf16 v[160:175], v[216:219], v[80:83], 0
    s_waitcnt lgkmcnt(7)
    ds_read_b64_tr_b16 v[238:239], v5 offset:34920
    v_mfma_f32_32x32x16_bf16 v[176:191], v[220:223], v[80:83], 0
    s_waitcnt vmcnt(16) lgkmcnt(6)
    v_exp_f32 v22, v22
    v_exp_f32_e64 v23, v23
    v_cvt_pk_bf16_f32 v50, v20, v21
    v_mfma_f32_32x32x16_bf16 v[128:143], v[224:227], v[84:87], v[128:143]
    ds_read_b64_tr_b16 v[208:209], v5 offset:35200
    ds_read_b64_tr_b16 v[210:211], v5 offset:35648
WPAD49:
    s_cbranch_execz WRET0
    buffer_load_dwordx4 v[80:83], v1, s[32:35], s74 offen offset:0 sc1
    v_exp_f32 v24, v24
    v_exp_f32 v25, v25
    v_cvt_pk_bf16_f32 v51, v22, v23
    v_mfma_f32_32x32x16_bf16 a[144:159], a[232:235], v[56:59], a[144:159]
    s_waitcnt lgkmcnt(6)
    ds_read_b64_tr_b16 v[212:213], v5 offset:35256
    ds_read_b64_tr_b16 v[214:215], v5 offset:35704
    v_mfma_f32_32x32x16_bf16 v[144:159], v[228:231], v[84:87], v[144:159]
    ds_read_b64_tr_b16 v[216:217], v5 offset:35312
    ds_read_b64_tr_b16 v[218:219], v5 offset:35760
    v_exp_f32 v26, v26
    v_exp_f32 v27, v27
    v_cvt_pk_bf16_f32 v52, v24, v25
    v_mfma_f32_32x32x16_bf16 a[144:159], a[236:239], v[60:63], a[144:159]
    s_waitcnt lgkmcnt(8)
    ds_read_b64_tr_b16 v[220:221], v5 offset:35368
    v_exp_f32 v28, v28
    v_exp_f32 v29, v29
    v_cvt_pk_bf16_f32 v53, v26, v27
    v_mfma_f32_32x32x16_bf16 v[160:175], v[232:235], v[84:87], v[160:175]
    s_waitcnt lgkmcnt(7)
    ds_read_b64_tr_b16 v[222:223], v5 offset:35816
    v_mfma_f32_32x32x16_bf16 v[176:191], v[236:239], v[84:87], v[176:191]
    s_waitcnt vmcnt(16) lgkmcnt(6)
    v_exp_f32 v30, v30
    v_exp_f32 v31, v31
    v_cvt_pk_bf16_f32 v54, v28, v29
    v_mfma_f32_32x32x16_bf16 v[128:143], v[208:211], v[88:91], v[128:143]
    ds_read_b64_tr_b16 v[224:225], v5 offset:36096
    ds_read_b64_tr_b16 v[226:227], v5 offset:36544
    buffer_load_dwordx4 a[196:199], v1, s[32:35], s69 offen offset:1024 sc1
    buffer_load_dwordx4 a[200:203], v1, s[32:35], s69 offen offset:2048 sc1
    v_exp_f32 v32, v32
    v_exp_f32 v33, v33
    v_cvt_pk_bf16_f32 v55, v30, v31
    v_mfma_f32_32x32x16_bf16 v[16:31], a[32:35], a[96:99], 0
    s_waitcnt lgkmcnt(6)
    ds_read_b64_tr_b16 v[228:229], v5 offset:36152
    ds_read_b64_tr_b16 v[230:231], v5 offset:36600
    buffer_load_dwordx4 v[84:87], v1, s[32:35], s74 offen offset:1024 sc1
    v_mfma_f32_32x32x16_bf16 v[144:159], v[212:215], v[88:91], v[144:159]
    ds_read_b64_tr_b16 v[232:233], v5 offset:36208
    ds_read_b64_tr_b16 v[234:235], v5 offset:36656
    v_exp_f32 v34, v34
    v_exp_f32 v35, v35
    v_cvt_pk_bf16_f32 v56, v32, v33
    v_mfma_f32_32x32x16_bf16 v[16:31], a[36:39], a[100:103], v[16:31]
    s_waitcnt lgkmcnt(8)
    ds_read_b64_tr_b16 v[236:237], v5 offset:36264
    v_exp_f32 v36, v36
    v_exp_f32 v37, v37
    v_cvt_pk_bf16_f32 v57, v34, v35
    v_mfma_f32_32x32x16_bf16 v[160:175], v[216:219], v[88:91], v[160:175]
    s_waitcnt lgkmcnt(7)
    ds_read_b64_tr_b16 v[238:239], v5 offset:36712
    v_mfma_f32_32x32x16_bf16 v[176:191], v[220:223], v[88:91], v[176:191]
    s_waitcnt vmcnt(18) lgkmcnt(6)
    v_exp_f32 v38, v38
    v_exp_f32 v39, v39
    v_cvt_pk_bf16_f32 v58, v36, v37
    v_mfma_f32_32x32x16_bf16 v[128:143], v[224:227], v[92:95], v[128:143]
    ds_read_b64_tr_b16 v[208:209], v5 offset:37120
    ds_read_b64_tr_b16 v[210:211], v5 offset:37568
    buffer_load_dwordx4 v[88:91], v1, s[32:35], s74 offen offset:2048 sc1
    v_exp_f32 v40, v40
    v_exp_f32 v41, v41
    v_cvt_pk_bf16_f32 v59, v38, v39
    v_mfma_f32_32x32x16_bf16 a[160:175], a[232:235], v[48:51], a[160:175]
    s_waitcnt lgkmcnt(6)
    ds_read_b64_tr_b16 v[212:213], v5 offset:37176
    ds_read_b64_tr_b16 v[214:215], v5 offset:37624
    v_mfma_f32_32x32x16_bf16 v[144:159], v[228:231], v[92:95], v[144:159]
    ds_read_b64_tr_b16 v[216:217], v5 offset:37232
    ds_read_b64_tr_b16 v[218:219], v5 offset:37680
    v_exp_f32 v42, v42
    v_exp_f32 v43, v43
    v_cvt_pk_bf16_f32 v60, v40, v41
WPAD50:
    s_cbranch_execz WRET0
    v_mfma_f32_32x32x16_bf16 a[160:175], a[236:239], v[52:55], a[160:175]
    s_waitcnt lgkmcnt(8)
    ds_read_b64_tr_b16 v[220:221], v5 offset:37288
    v_exp_f32 v44, v44
    v_exp_f32 v45, v45
    v_cvt_pk_bf16_f32 v61, v42, v43
    v_mfma_f32_32x32x16_bf16 v[160:175], v[232:235], v[92:95], v[160:175]
    s_waitcnt lgkmcnt(7)
    ds_read_b64_tr_b16 v[222:223], v5 offset:37736
    v_mfma_f32_32x32x16_bf16 v[176:191], v[236:239], v[92:95], v[176:191]
    s_waitcnt vmcnt(18) lgkmcnt(6)
    v_exp_f32 v46, v46
    v_exp_f32 v47, v47
    v_cvt_pk_bf16_f32 v62, v44, v45
    v_mfma_f32_32x32x16_bf16 v[128:143], v[208:211], v[96:99], v[128:143]
    ds_read_b64_tr_b16 v[224:225], v5 offset:38016
    ds_read_b64_tr_b16 v[226:227], v5 offset:38464
    buffer_load_dwordx4 a[204:207], v1, s[32:35], s69 offen offset:3072 sc1
    s_add_u32 s69, s69, 4096
    v_exp_f32 v16, v16
    v_exp_f32 v17, v17
    v_cvt_pk_bf16_f32 v63, v46, v47
    v_mfma_f32_32x32x16_bf16 v[32:47], a[32:35], a[104:107], 0
    s_waitcnt lgkmcnt(6)
    ds_read_b64_tr_b16 v[228:229], v5 offset:38072
    ds_read_b64_tr_b16 v[230:231], v5 offset:38520
    buffer_load_dwordx4 v[92:95], v1, s[32:35], s74 offen offset:3072 sc1
    s_add_u32 s74, s74, 4096
    v_mfma_f32_32x32x16_bf16 v[144:159], v[212:215], v[96:99], v[144:159]
    ds_read_b64_tr_b16 v[232:233], v5 offset:38128
    ds_read_b64_tr_b16 v[234:235], v5 offset:38576
    v_exp_f32 v18, v18
    v_exp_f32 v19, v19
    v_cvt_pk_bf16_f32 v48, v16, v17
    v_mfma_f32_32x32x16_bf16 v[32:47], a[36:39], a[108:111], v[32:47]
    s_waitcnt lgkmcnt(8)
    ds_read_b64_tr_b16 v[236:237], v5 offset:38184
    v_exp_f32 v20, v20
    v_exp_f32 v21, v21
    v_cvt_pk_bf16_f32 v49, v18, v19
    v_mfma_f32_32x32x16_bf16 v[160:175], v[216:219], v[96:99], v[160:175]
    s_waitcnt lgkmcnt(7)
    ds_read_b64_tr_b16 v[238:239], v5 offset:38632
    v_mfma_f32_32x32x16_bf16 v[176:191], v[220:223], v[96:99], v[176:191]
    s_waitcnt vmcnt(19) lgkmcnt(6)
    v_exp_f32 v22, v22
    v_exp_f32 v23, v23
    v_cvt_pk_bf16_f32 v50, v20, v21
    v_mfma_f32_32x32x16_bf16 v[128:143], v[224:227], v[100:103], v[128:143]
    ds_read_b64_tr_b16 v[208:209], v5 offset:38912
    ds_read_b64_tr_b16 v[210:211], v5 offset:39360
    buffer_load_dwordx4 v[96:99], v1, s[32:35], s74 offen offset:0 sc1
    v_exp_f32 v24, v24
    v_exp_f32 v25, v25
    v_cvt_pk_bf16_f32 v51, v22, v23
    v_mfma_f32_32x32x16_bf16 v[64:79], a[232:235], v[56:59], v[64:79]
    s_waitcnt lgkmcnt(6)
    ds_read_b64_tr_b16 v[212:213], v5 offset:38968
    ds_read_b64_tr_b16 v[214:215], v5 offset:39416
    v_mfma_f32_32x32x16_bf16 v[144:159], v[228:231], v[100:103], v[144:159]
    ds_read_b64_tr_b16 v[216:217], v5 offset:39024
    ds_read_b64_tr_b16 v[218:219], v5 offset:39472
    v_exp_f32 v26, v26
    v_exp_f32 v27, v27
    v_cvt_pk_bf16_f32 v52, v24, v25
    v_mfma_f32_32x32x16_bf16 v[64:79], a[236:239], v[60:63], v[64:79]
    s_waitcnt lgkmcnt(8)
    ds_read_b64_tr_b16 v[220:221], v5 offset:39080
    v_exp_f32 v28, v28
    v_exp_f32 v29, v29
    v_cvt_pk_bf16_f32 v53, v26, v27
    v_mfma_f32_32x32x16_bf16 v[160:175], v[232:235], v[100:103], v[160:175]
    s_waitcnt lgkmcnt(7)
    ds_read_b64_tr_b16 v[222:223], v5 offset:39528
    v_mfma_f32_32x32x16_bf16 v[176:191], v[236:239], v[100:103], v[176:191]
    s_waitcnt vmcnt(19) lgkmcnt(6)
    v_exp_f32 v30, v30
    v_exp_f32 v31, v31
    v_cvt_pk_bf16_f32 v54, v28, v29
WPAD51:
    s_cbranch_execz WRET0
    v_mfma_f32_32x32x16_bf16 v[128:143], v[208:211], v[104:107], v[128:143]
    ds_read_b64_tr_b16 v[224:225], v5 offset:39808
    ds_read_b64_tr_b16 v[226:227], v5 offset:40256
    buffer_load_dwordx4 a[208:211], v1, s[32:35], s69 offen offset:0 sc1
    buffer_load_dwordx4 a[212:215], v1, s[32:35], s69 offen offset:1024 sc1
    v_exp_f32 v32, v32
    v_exp_f32 v33, v33
    v_cvt_pk_bf16_f32 v55, v30, v31
    v_mfma_f32_32x32x16_bf16 v[16:31], a[32:35], a[112:115], 0
    s_waitcnt lgkmcnt(6)
    ds_read_b64_tr_b16 v[228:229], v5 offset:39864
    ds_read_b64_tr_b16 v[230:231], v5 offset:40312
    buffer_load_dwordx4 v[100:103], v1, s[32:35], s74 offen offset:1024 sc1
    v_mfma_f32_32x32x16_bf16 v[144:159], v[212:215], v[104:107], v[144:159]
    ds_read_b64_tr_b16 v[232:233], v5 offset:39920
    ds_read_b64_tr_b16 v[234:235], v5 offset:40368
    v_exp_f32 v34, v34
    v_exp_f32 v35, v35
    v_cvt_pk_bf16_f32 v56, v32, v33
    v_mfma_f32_32x32x16_bf16 v[16:31], a[36:39], a[116:119], v[16:31]
    s_waitcnt lgkmcnt(8)
    ds_read_b64_tr_b16 v[236:237], v5 offset:39976
    v_exp_f32 v36, v36
    v_exp_f32 v37, v37
    v_cvt_pk_bf16_f32 v57, v34, v35
    v_mfma_f32_32x32x16_bf16 v[160:175], v[216:219], v[104:107], v[160:175]
    s_waitcnt lgkmcnt(7)
    ds_read_b64_tr_b16 v[238:239], v5 offset:40424
    v_mfma_f32_32x32x16_bf16 v[176:191], v[220:223], v[104:107], v[176:191]
    s_waitcnt vmcnt(21) lgkmcnt(6)
    v_exp_f32 v38, v38
    v_exp_f32 v39, v39
    v_cvt_pk_bf16_f32 v58, v36, v37
    v_mfma_f32_32x32x16_bf16 v[128:143], v[224:227], v[108:111], v[128:143]
    ds_read_b64_tr_b16 v[208:209], v5 offset:3712
    ds_read_b64_tr_b16 v[210:211], v5 offset:4160
    buffer_load_dwordx4 v[104:107], v1, s[32:35], s74 offen offset:2048 sc1
    v_exp_f32 v40, v40
    v_exp_f32 v41, v41
    v_cvt_pk_bf16_f32 v59, v38, v39
    v_mfma_f32_32x32x16_bf16 a[128:143], a[40:43], v[48:51], a[128:143]
    s_waitcnt lgkmcnt(6)
    ds_read_b64_tr_b16 v[212:213], v5 offset:3768
    ds_read_b64_tr_b16 v[214:215], v5 offset:4216
    v_mfma_f32_32x32x16_bf16 v[144:159], v[228:231], v[108:111], v[144:159]
    ds_read_b64_tr_b16 v[216:217], v5 offset:3824
    ds_read_b64_tr_b16 v[218:219], v5 offset:4272
    v_exp_f32 v42, v42
    v_exp_f32 v43, v43
    v_cvt_pk_bf16_f32 v60, v40, v41
    v_mfma_f32_32x32x16_bf16 a[128:143], a[44:47], v[52:55], a[128:143]
    s_waitcnt lgkmcnt(8)
    ds_read_b64_tr_b16 v[220:221], v5 offset:3880
    v_exp_f32 v44, v44
    v_exp_f32 v45, v45
    v_cvt_pk_bf16_f32 v61, v42, v43
    v_mfma_f32_32x32x16_bf16 v[160:175], v[232:235], v[108:111], v[160:175]
    s_waitcnt lgkmcnt(7)
    ds_read_b64_tr_b16 v[222:223], v5 offset:4328
    v_mfma_f32_32x32x16_bf16 v[176:191], v[236:239], v[108:111], v[176:191]
    s_waitcnt vmcnt(21) lgkmcnt(6)
    v_exp_f32 v46, v46
    v_exp_f32 v47, v47
    v_cvt_pk_bf16_f32 v62, v44, v45
    v_mfma_f32_32x32x16_bf16 v[128:143], v[208:211], v[112:115], v[128:143]
    ds_read_b64_tr_b16 v[224:225], v5 offset:4608
    ds_read_b64_tr_b16 v[226:227], v5 offset:5056
    buffer_load_dwordx4 a[216:219], v1, s[32:35], s69 offen offset:2048 sc1
    buffer_load_dwordx4 v[108:111], v1, s[32:35], s74 offen offset:3072 sc1
    v_exp_f32 v16, v16
    v_exp_f32 v17, v17
    v_cvt_pk_bf16_f32 v63, v46, v47
    v_mfma_f32_32x32x16_bf16 v[32:47], a[32:35], a[120:123], 0
    s_waitcnt lgkmcnt(6)
    ds_read_b64_tr_b16 v[228:229], v5 offset:4664
    ds_read_b64_tr_b16 v[230:231], v5 offset:5112
    s_add_u32 s74, s74, 4096
WPAD52:
    s_cbranch_execz WRET0
    v_mfma_f32_32x32x16_bf16 v[144:159], v[212:215], v[112:115], v[144:159]
    ds_read_b64_tr_b16 v[232:233], v5 offset:4720
    ds_read_b64_tr_b16 v[234:235], v5 offset:5168
    v_exp_f32 v18, v18
    v_exp_f32 v19, v19
    v_cvt_pk_bf16_f32 v48, v16, v17
    v_mfma_f32_32x32x16_bf16 v[32:47], a[36:39], a[124:127], v[32:47]
    s_waitcnt lgkmcnt(8)
    ds_read_b64_tr_b16 v[236:237], v5 offset:4776
    v_exp_f32 v20, v20
    v_exp_f32 v21, v21
    v_cvt_pk_bf16_f32 v49, v18, v19
    v_mfma_f32_32x32x16_bf16 v[160:175], v[216:219], v[112:115], v[160:175]
    s_waitcnt lgkmcnt(7)
    ds_read_b64_tr_b16 v[238:239], v5 offset:5224
    v_mfma_f32_32x32x16_bf16 v[176:191], v[220:223], v[112:115], v[176:191]
    s_waitcnt vmcnt(22) lgkmcnt(6)
    v_exp_f32 v22, v22
    v_exp_f32 v23, v23
    v_cvt_pk_bf16_f32 v50, v20, v21
    v_mfma_f32_32x32x16_bf16 v[128:143], v[224:227], v[116:119], v[128:143]
    ds_read_b64_tr_b16 v[208:209], v5 offset:5504
    ds_read_b64_tr_b16 v[210:211], v5 offset:5952
    buffer_load_dwordx4 v[112:115], v1, s[32:35], s74 offen offset:0 sc1
    v_exp_f32 v24, v24
    v_exp_f32 v25, v25
    v_cvt_pk_bf16_f32 v51, v22, v23
    v_mfma_f32_32x32x16_bf16 a[144:159], a[40:43], v[56:59], a[144:159]
    s_waitcnt lgkmcnt(6)
    ds_read_b64_tr_b16 v[212:213], v5 offset:5560
    ds_read_b64_tr_b16 v[214:215], v5 offset:6008
    v_mfma_f32_32x32x16_bf16 v[144:159], v[228:231], v[116:119], v[144:159]
    ds_read_b64_tr_b16 v[216:217], v5 offset:5616
    ds_read_b64_tr_b16 v[218:219], v5 offset:6064
    v_exp_f32 v26, v26
    v_exp_f32 v27, v27
    v_cvt_pk_bf16_f32 v52, v24, v25
    v_mfma_f32_32x32x16_bf16 a[144:159], a[44:47], v[60:63], a[144:159]
    s_waitcnt lgkmcnt(8)
    ds_read_b64_tr_b16 v[220:221], v5 offset:5672
    v_exp_f32 v28, v28
    v_exp_f32 v29, v29
    v_cvt_pk_bf16_f32 v53, v26, v27
    v_mfma_f32_32x32x16_bf16 v[160:175], v[232:235], v[116:119], v[160:175]
    s_waitcnt lgkmcnt(7)
    ds_read_b64_tr_b16 v[222:223], v5 offset:6120
    v_mfma_f32_32x32x16_bf16 v[176:191], v[236:239], v[116:119], v[176:191]
    s_waitcnt vmcnt(22) lgkmcnt(6)
    v_exp_f32 v30, v30
    v_exp_f32 v31, v31
    v_cvt_pk_bf16_f32 v54, v28, v29
    v_mfma_f32_32x32x16_bf16 v[128:143], v[208:211], v[120:123], v[128:143]
    ds_read_b64_tr_b16 v[224:225], v5 offset:6400
    ds_read_b64_tr_b16 v[226:227], v5 offset:6848
    buffer_load_dwordx4 a[220:223], v1, s[32:35], s69 offen offset:3072 sc1
    s_add_u32 s69, s69, 4096
    v_exp_f32 v32, v32
    v_exp_f32 v33, v33
    v_cvt_pk_bf16_f32 v55, v30, v31
    v_mfma_f32_32x32x16_bf16 v[16:31], a[48:51], a[96:99], 0
    s_waitcnt lgkmcnt(6)
    ds_read_b64_tr_b16 v[228:229], v5 offset:6456
    ds_read_b64_tr_b16 v[230:231], v5 offset:6904
    buffer_load_dwordx4 a[224:227], v1, s[32:35], s69 offen offset:0 sc1
    buffer_load_dwordx4 v[116:119], v1, s[32:35], s74 offen offset:1024 sc1
    v_mfma_f32_32x32x16_bf16 v[144:159], v[212:215], v[120:123], v[144:159]
    ds_read_b64_tr_b16 v[232:233], v5 offset:6512
    ds_read_b64_tr_b16 v[234:235], v5 offset:6960
    v_exp_f32 v34, v34
    v_exp_f32 v35, v35
    v_cvt_pk_bf16_f32 v56, v32, v33
    v_mfma_f32_32x32x16_bf16 v[16:31], a[52:55], a[100:103], v[16:31]
    s_waitcnt lgkmcnt(8)
    ds_read_b64_tr_b16 v[236:237], v5 offset:6568
    v_exp_f32 v36, v36
    v_exp_f32 v37, v37
    v_cvt_pk_bf16_f32 v57, v34, v35
    v_mfma_f32_32x32x16_bf16 v[160:175], v[216:219], v[120:123], v[160:175]
WPAD53:
    s_cbranch_execz WRET0
    s_waitcnt lgkmcnt(7)
    ds_read_b64_tr_b16 v[238:239], v5 offset:7016
    v_mfma_f32_32x32x16_bf16 v[176:191], v[220:223], v[120:123], v[176:191]
    s_waitcnt vmcnt(24) lgkmcnt(6)
    v_exp_f32 v38, v38
    v_exp_f32 v39, v39
    v_cvt_pk_bf16_f32 v58, v36, v37
    v_mfma_f32_32x32x16_bf16 v[128:143], v[224:227], v[124:127], v[128:143]
    s_barrier
    ds_read_b64_tr_b16 v[208:209], v5 offset:7424
    ds_read_b64_tr_b16 v[210:211], v5 offset:7872
    buffer_load_dwordx4 v[120:123], v1, s[32:35], s74 offen offset:2048 sc1
    v_exp_f32 v40, v40
    v_exp_f32 v41, v41
    v_cvt_pk_bf16_f32 v59, v38, v39
    v_mfma_f32_32x32x16_bf16 a[160:175], a[40:43], v[48:51], a[160:175]
    s_waitcnt lgkmcnt(6)
    ds_read_b64_tr_b16 v[212:213], v5 offset:7480
    ds_read_b64_tr_b16 v[214:215], v5 offset:7928
    v_mfma_f32_32x32x16_bf16 v[144:159], v[228:231], v[124:127], v[144:159]
    ds_read_b64_tr_b16 v[216:217], v5 offset:7536
    ds_read_b64_tr_b16 v[218:219], v5 offset:7984
    v_exp_f32 v42, v42
    v_exp_f32 v43, v43
    v_cvt_pk_bf16_f32 v60, v40, v41
    v_mfma_f32_32x32x16_bf16 a[160:175], a[44:47], v[52:55], a[160:175]
    s_waitcnt lgkmcnt(8)
    ds_read_b64_tr_b16 v[220:221], v5 offset:7592
    v_exp_f32 v44, v44
    v_exp_f32 v45, v45
    v_cvt_pk_bf16_f32 v61, v42, v43
    v_mfma_f32_32x32x16_bf16 v[160:175], v[232:235], v[124:127], v[160:175]
    s_waitcnt lgkmcnt(7)
    ds_read_b64_tr_b16 v[222:223], v5 offset:8040
    v_mfma_f32_32x32x16_bf16 v[176:191], v[236:239], v[124:127], v[176:191]
    s_waitcnt vmcnt(18) lgkmcnt(6)
    v_exp_f32 v46, v46
    v_exp_f32 v47, v47
    v_cvt_pk_bf16_f32 v62, v44, v45
    v_mfma_f32_32x32x16_bf16 v[128:143], v[208:211], v[80:83], v[128:143]
    ds_read_b64_tr_b16 v[224:225], v5 offset:8320
    ds_read_b64_tr_b16 v[226:227], v5 offset:8768
    buffer_load_dwordx4 a[228:231], v1, s[32:35], s69 offen offset:1024 sc1
    buffer_load_dwordx4 v[124:127], v1, s[32:35], s74 offen offset:3072 sc1
    v_exp_f32 v16, v16
    v_exp_f32 v17, v17
    v_cvt_pk_bf16_f32 v63, v46, v47
    v_mfma_f32_32x32x16_bf16 v[32:47], a[48:51], a[104:107], 0
    s_waitcnt lgkmcnt(6)
    ds_read_b64_tr_b16 v[228:229], v5 offset:8376
    ds_read_b64_tr_b16 v[230:231], v5 offset:8824
    s_add_u32 s74, s74, 4096
    v_mfma_f32_32x32x16_bf16 v[144:159], v[212:215], v[80:83], v[144:159]
    ds_read_b64_tr_b16 v[232:233], v5 offset:8432
    ds_read_b64_tr_b16 v[234:235], v5 offset:8880
    v_exp_f32 v18, v18
    v_exp_f32 v19, v19
    v_cvt_pk_bf16_f32 v48, v16, v17
    v_mfma_f32_32x32x16_bf16 v[32:47], a[52:55], a[108:111], v[32:47]
    s_waitcnt lgkmcnt(8)
    ds_read_b64_tr_b16 v[236:237], v5 offset:8488
    v_exp_f32 v20, v20
    v_exp_f32 v21, v21
    v_cvt_pk_bf16_f32 v49, v18, v19
    v_mfma_f32_32x32x16_bf16 v[160:175], v[216:219], v[80:83], v[160:175]
    s_waitcnt lgkmcnt(7)
    ds_read_b64_tr_b16 v[238:239], v5 offset:8936
    v_mfma_f32_32x32x16_bf16 v[176:191], v[220:223], v[80:83], v[176:191]
    s_waitcnt vmcnt(17) lgkmcnt(6)
    v_exp_f32 v22, v22
    v_exp_f32 v23, v23
    v_cvt_pk_bf16_f32 v50, v20, v21
    v_mfma_f32_32x32x16_bf16 v[128:143], v[224:227], v[84:87], v[128:143]
    ds_read_b64_tr_b16 v[208:209], v5 offset:9216
    ds_read_b64_tr_b16 v[210:211], v5 offset:9664
    buffer_load_dwordx4 v[80:83], v1, s[32:35], s74 offen offset:0 sc1
    v_exp_f32 v24, v24
    v_exp_f32 v25, v25
    v_cvt_pk_bf16_f32 v51, v22, v23
WPAD54:
    s_cbranch_execz WRET0
    v_mfma_f32_32x32x16_bf16 v[64:79], a[40:43], v[56:59], v[64:79]
    s_waitcnt lgkmcnt(6)
    ds_read_b64_tr_b16 v[212:213], v5 offset:9272
    ds_read_b64_tr_b16 v[214:215], v5 offset:9720
    v_mfma_f32_32x32x16_bf16 v[144:159], v[228:231], v[84:87], v[144:159]
    ds_read_b64_tr_b16 v[216:217], v5 offset:9328
    ds_read_b64_tr_b16 v[218:219], v5 offset:9776
    v_exp_f32 v26, v26
    v_exp_f32 v27, v27
    v_cvt_pk_bf16_f32 v52, v24, v25
    v_mfma_f32_32x32x16_bf16 v[64:79], a[44:47], v[60:63], v[64:79]
    s_waitcnt lgkmcnt(8)
    ds_read_b64_tr_b16 v[220:221], v5 offset:9384
    v_exp_f32 v28, v28
    v_exp_f32 v29, v29
    v_cvt_pk_bf16_f32 v53, v26, v27
    v_mfma_f32_32x32x16_bf16 v[160:175], v[232:235], v[84:87], v[160:175]
    s_waitcnt lgkmcnt(7)
    ds_read_b64_tr_b16 v[222:223], v5 offset:9832
    v_mfma_f32_32x32x16_bf16 v[176:191], v[236:239], v[84:87], v[176:191]
    s_waitcnt vmcnt(17) lgkmcnt(6)
    v_exp_f32 v30, v30
    v_exp_f32 v31, v31
    v_cvt_pk_bf16_f32 v54, v28, v29
    v_mfma_f32_32x32x16_bf16 v[128:143], v[208:211], v[88:91], v[128:143]
    ds_read_b64_tr_b16 v[224:225], v5 offset:10112
    ds_read_b64_tr_b16 v[226:227], v5 offset:10560
    buffer_load_dwordx4 a[232:235], v1, s[32:35], s69 offen offset:2048 sc1
    buffer_load_dwordx4 a[236:239], v1, s[32:35], s69 offen offset:3072 sc1
    v_exp_f32 v32, v32
    v_exp_f32 v33, v33
    v_cvt_pk_bf16_f32 v55, v30, v31
    v_mfma_f32_32x32x16_bf16 v[16:31], a[48:51], a[112:115], 0
    s_waitcnt lgkmcnt(6)
    ds_read_b64_tr_b16 v[228:229], v5 offset:10168
    ds_read_b64_tr_b16 v[230:231], v5 offset:10616
    s_add_u32 s69, s69, 4096
    buffer_load_dwordx4 v[84:87], v1, s[32:35], s74 offen offset:1024 sc1
    v_mfma_f32_32x32x16_bf16 v[144:159], v[212:215], v[88:91], v[144:159]
    ds_read_b64_tr_b16 v[232:233], v5 offset:10224
    ds_read_b64_tr_b16 v[234:235], v5 offset:10672
    v_exp_f32 v34, v34
    v_exp_f32 v35, v35
    v_cvt_pk_bf16_f32 v56, v32, v33
    v_mfma_f32_32x32x16_bf16 v[16:31], a[52:55], a[116:119], v[16:31]
    s_waitcnt lgkmcnt(8)
    ds_read_b64_tr_b16 v[236:237], v5 offset:10280
    v_exp_f32 v36, v36
    v_exp_f32 v37, v37
    v_cvt_pk_bf16_f32 v57, v34, v35
    v_mfma_f32_32x32x16_bf16 v[160:175], v[216:219], v[88:91], v[160:175]
    s_waitcnt lgkmcnt(7)
    ds_read_b64_tr_b16 v[238:239], v5 offset:10728
    v_mfma_f32_32x32x16_bf16 v[176:191], v[220:223], v[88:91], v[176:191]
    s_waitcnt vmcnt(18) lgkmcnt(6)
    v_exp_f32 v38, v38
    v_exp_f32 v39, v39
    v_cvt_pk_bf16_f32 v58, v36, v37
    v_mfma_f32_32x32x16_bf16 v[128:143], v[224:227], v[92:95], v[128:143]
    ds_read_b64_tr_b16 v[208:209], v5 offset:11136
    ds_read_b64_tr_b16 v[210:211], v5 offset:11584
    buffer_load_dwordx4 v[88:91], v1, s[32:35], s74 offen offset:2048 sc1
    v_exp_f32 v40, v40
    v_exp_f32 v41, v41
    v_cvt_pk_bf16_f32 v59, v38, v39
    v_mfma_f32_32x32x16_bf16 a[128:143], a[56:59], v[48:51], a[128:143]
    s_waitcnt lgkmcnt(6)
    ds_read_b64_tr_b16 v[212:213], v5 offset:11192
    ds_read_b64_tr_b16 v[214:215], v5 offset:11640
    v_mfma_f32_32x32x16_bf16 v[144:159], v[228:231], v[92:95], v[144:159]
    ds_read_b64_tr_b16 v[216:217], v5 offset:11248
    ds_read_b64_tr_b16 v[218:219], v5 offset:11696
    v_exp_f32 v42, v42
    v_exp_f32_e64 v43, v43
    v_cvt_pk_bf16_f32 v60, v40, v41
    v_mfma_f32_32x32x16_bf16 a[128:143], a[60:63], v[52:55], a[128:143]
    s_waitcnt lgkmcnt(8)
WPAD55:
    s_cbranch_execz WRET0
    ds_read_b64_tr_b16 v[220:221], v5 offset:11304
    v_exp_f32 v44, v44
    v_exp_f32 v45, v45
    v_cvt_pk_bf16_f32 v61, v42, v43
    v_mfma_f32_32x32x16_bf16 v[160:175], v[232:235], v[92:95], v[160:175]
    s_waitcnt lgkmcnt(7)
    ds_read_b64_tr_b16 v[222:223], v5 offset:11752
    v_mfma_f32_32x32x16_bf16 v[176:191], v[236:239], v[92:95], v[176:191]
    s_waitcnt vmcnt(18) lgkmcnt(6)
    v_exp_f32 v46, v46
    v_exp_f32 v47, v47
    v_cvt_pk_bf16_f32 v62, v44, v45
    v_mfma_f32_32x32x16_bf16 v[128:143], v[208:211], v[96:99], v[128:143]
    ds_read_b64_tr_b16 v[224:225], v5 offset:12032
    ds_read_b64_tr_b16 v[226:227], v5 offset:12480
    buffer_load_dwordx4 a[32:35], v1, s[32:35], s69 offen offset:0 sc1
    buffer_load_dwordx4 v[92:95], v1, s[32:35], s74 offen offset:3072 sc1
    v_exp_f32 v16, v16
    v_exp_f32 v17, v17
    v_cvt_pk_bf16_f32 v63, v46, v47
    v_mfma_f32_32x32x16_bf16 v[32:47], a[48:51], a[120:123], 0
    s_waitcnt lgkmcnt(6)
    ds_read_b64_tr_b16 v[228:229], v5 offset:12088
    ds_read_b64_tr_b16 v[230:231], v5 offset:12536
    s_add_u32 s74, s74, 4096
    v_mfma_f32_32x32x16_bf16 v[144:159], v[212:215], v[96:99], v[144:159]
    ds_read_b64_tr_b16 v[232:233], v5 offset:12144
    ds_read_b64_tr_b16 v[234:235], v5 offset:12592
    v_exp_f32 v18, v18
    v_exp_f32 v19, v19
    v_cvt_pk_bf16_f32 v48, v16, v17
    v_mfma_f32_32x32x16_bf16 v[32:47], a[52:55], a[124:127], v[32:47]
    s_waitcnt lgkmcnt(8)
    ds_read_b64_tr_b16 v[236:237], v5 offset:12200
    v_exp_f32 v20, v20
    v_exp_f32 v21, v21
    v_cvt_pk_bf16_f32 v49, v18, v19
    v_mfma_f32_32x32x16_bf16 v[160:175], v[216:219], v[96:99], v[160:175]
    s_waitcnt lgkmcnt(7)
    ds_read_b64_tr_b16 v[238:239], v5 offset:12648
    v_mfma_f32_32x32x16_bf16 v[176:191], v[220:223], v[96:99], v[176:191]
    s_waitcnt vmcnt(17) lgkmcnt(6)
    v_exp_f32 v22, v22
    v_exp_f32 v23, v23
    v_cvt_pk_bf16_f32 v50, v20, v21
    v_mfma_f32_32x32x16_bf16 v[128:143], v[224:227], v[100:103], v[128:143]
    ds_read_b64_tr_b16 v[208:209], v5 offset:12928
    ds_read_b64_tr_b16 v[210:211], v5 offset:13376
    v_exp_f32 v24, v24
    v_exp_f32 v25, v25
    v_cvt_pk_bf16_f32 v51, v22, v23
    v_mfma_f32_32x32x16_bf16 a[144:159], a[56:59], v[56:59], a[144:159]
    s_waitcnt lgkmcnt(6)
    ds_read_b64_tr_b16 v[212:213], v5 offset:12984
    ds_read_b64_tr_b16 v[214:215], v5 offset:13432
    v_mfma_f32_32x32x16_bf16 v[144:159], v[228:231], v[100:103], v[144:159]
    ds_read_b64_tr_b16 v[216:217], v5 offset:13040
    ds_read_b64_tr_b16 v[218:219], v5 offset:13488
    v_exp_f32 v26, v26
    v_exp_f32 v27, v27
    v_cvt_pk_bf16_f32 v52, v24, v25
    v_mfma_f32_32x32x16_bf16 a[144:159], a[60:63], v[60:63], a[144:159]
    s_waitcnt lgkmcnt(8)
    ds_read_b64_tr_b16 v[220:221], v5 offset:13096
    v_exp_f32 v28, v28
    v_exp_f32 v29, v29
    v_cvt_pk_bf16_f32 v53, v26, v27
    v_mfma_f32_32x32x16_bf16 v[160:175], v[232:235], v[100:103], v[160:175]
    s_waitcnt lgkmcnt(7)
    ds_read_b64_tr_b16 v[222:223], v5 offset:13544
    v_mfma_f32_32x32x16_bf16 v[176:191], v[236:239], v[100:103], v[176:191]
    s_waitcnt vmcnt(16) lgkmcnt(6)
    v_exp_f32 v30, v30
    v_exp_f32_e64 v31, v31
    v_cvt_pk_bf16_f32 v54, v28, v29
    v_mfma_f32_32x32x16_bf16 v[128:143], v[208:211], v[104:107], v[128:143]
    ds_read_b64_tr_b16 v[224:225], v5 offset:13824
    ds_read_b64_tr_b16 v[226:227], v5 offset:14272
WPAD56:
    s_cbranch_execz WRET0
    buffer_load_dwordx4 a[36:39], v1, s[32:35], s69 offen offset:1024 sc1
    buffer_load_dwordx4 a[40:43], v1, s[32:35], s69 offen offset:2048 sc1
    v_exp_f32 v32, v32
    v_exp_f32 v33, v33
    v_cvt_pk_bf16_f32 v55, v30, v31
    v_mfma_f32_32x32x16_bf16 v[16:31], a[64:67], a[96:99], 0
    s_waitcnt lgkmcnt(6)
    ds_read_b64_tr_b16 v[228:229], v5 offset:13880
    ds_read_b64_tr_b16 v[230:231], v5 offset:14328
    v_mfma_f32_32x32x16_bf16 v[144:159], v[212:215], v[104:107], v[144:159]
    ds_read_b64_tr_b16 v[232:233], v5 offset:13936
    ds_read_b64_tr_b16 v[234:235], v5 offset:14384
    v_exp_f32 v34, v34
    v_exp_f32 v35, v35
    v_cvt_pk_bf16_f32 v56, v32, v33
    v_mfma_f32_32x32x16_bf16 v[16:31], a[68:71], a[100:103], v[16:31]
    s_waitcnt lgkmcnt(8)
    ds_read_b64_tr_b16 v[236:237], v5 offset:13992
    v_exp_f32 v36, v36
    v_exp_f32 v37, v37
    v_cvt_pk_bf16_f32 v57, v34, v35
    v_mfma_f32_32x32x16_bf16 v[160:175], v[216:219], v[104:107], v[160:175]
    s_waitcnt lgkmcnt(7)
    ds_read_b64_tr_b16 v[238:239], v5 offset:14440
    v_mfma_f32_32x32x16_bf16 v[176:191], v[220:223], v[104:107], v[176:191]
    s_waitcnt vmcnt(16) lgkmcnt(6)
    v_exp_f32 v38, v38
    v_exp_f32 v39, v39
    v_cvt_pk_bf16_f32 v58, v36, v37
    v_mfma_f32_32x32x16_bf16 v[128:143], v[224:227], v[108:111], v[128:143]
    ds_read_b64_tr_b16 v[208:209], v5 offset:14848
    ds_read_b64_tr_b16 v[210:211], v5 offset:15296
    v_exp_f32 v40, v40
    v_exp_f32 v41, v41
    v_cvt_pk_bf16_f32 v59, v38, v39
    v_mfma_f32_32x32x16_bf16 a[160:175], a[56:59], v[48:51], a[160:175]
    s_waitcnt lgkmcnt(6)
    ds_read_b64_tr_b16 v[212:213], v5 offset:14904
    ds_read_b64_tr_b16 v[214:215], v5 offset:15352
    v_mfma_f32_32x32x16_bf16 v[144:159], v[228:231], v[108:111], v[144:159]
    ds_read_b64_tr_b16 v[216:217], v5 offset:14960
    ds_read_b64_tr_b16 v[218:219], v5 offset:15408
    v_exp_f32 v42, v42
    v_exp_f32 v43, v43
    v_cvt_pk_bf16_f32 v60, v40, v41
    v_mfma_f32_32x32x16_bf16 a[160:175], a[60:63], v[52:55], a[160:175]
    s_waitcnt lgkmcnt(8)
    ds_read_b64_tr_b16 v[220:221], v5 offset:15016
    v_exp_f32 v44, v44
    v_exp_f32 v45, v45
    v_cvt_pk_bf16_f32 v61, v42, v43
    v_mfma_f32_32x32x16_bf16 v[160:175], v[232:235], v[108:111], v[160:175]
    s_waitcnt lgkmcnt(7)
    ds_read_b64_tr_b16 v[222:223], v5 offset:15464
    v_mfma_f32_32x32x16_bf16 v[176:191], v[236:239], v[108:111], v[176:191]
    s_waitcnt vmcnt(15) lgkmcnt(6)
    v_exp_f32 v46, v46
    v_exp_f32 v47, v47
    v_cvt_pk_bf16_f32 v62, v44, v45
    v_mfma_f32_32x32x16_bf16 v[128:143], v[208:211], v[112:115], v[128:143]
    ds_read_b64_tr_b16 v[224:225], v5 offset:15744
    ds_read_b64_tr_b16 v[226:227], v5 offset:16192
    buffer_load_dwordx4 a[44:47], v1, s[32:35], s69 offen offset:3072 sc1
    s_add_u32 s69, s69, 4096
    v_exp_f32 v16, v16
    v_exp_f32 v17, v17
    v_cvt_pk_bf16_f32 v63, v46, v47
    v_mfma_f32_32x32x16_bf16 v[32:47], a[64:67], a[104:107], 0
    s_waitcnt lgkmcnt(6)
    ds_read_b64_tr_b16 v[228:229], v5 offset:15800
    ds_read_b64_tr_b16 v[230:231], v5 offset:16248
    v_mfma_f32_32x32x16_bf16 v[144:159], v[212:215], v[112:115], v[144:159]
    ds_read_b64_tr_b16 v[232:233], v5 offset:15856
    ds_read_b64_tr_b16 v[234:235], v5 offset:16304
    v_exp_f32 v18, v18
    v_exp_f32 v19, v19
    v_cvt_pk_bf16_f32 v48, v16, v17
    v_mfma_f32_32x32x16_bf16 v[32:47], a[68:71], a[108:111], v[32:47]
WPAD57:
    s_cbranch_execz WRET0
    s_waitcnt lgkmcnt(8)
    ds_read_b64_tr_b16 v[236:237], v5 offset:15912
    v_exp_f32 v20, v20
    v_exp_f32 v21, v21
    v_cvt_pk_bf16_f32 v49, v18, v19
    v_mfma_f32_32x32x16_bf16 v[160:175], v[216:219], v[112:115], v[160:175]
    s_waitcnt lgkmcnt(7)
    ds_read_b64_tr_b16 v[238:239], v5 offset:16360
    v_mfma_f32_32x32x16_bf16 v[176:191], v[220:223], v[112:115], v[176:191]
    s_waitcnt vmcnt(13) lgkmcnt(6)
    v_exp_f32 v22, v22
    v_exp_f32 v23, v23
    v_cvt_pk_bf16_f32 v50, v20, v21
    v_mfma_f32_32x32x16_bf16 v[128:143], v[224:227], v[116:119], v[128:143]
    ds_read_b64_tr_b16 v[208:209], v5 offset:16640
    ds_read_b64_tr_b16 v[210:211], v5 offset:17088
    v_exp_f32 v24, v24
    v_exp_f32 v25, v25
    v_cvt_pk_bf16_f32 v51, v22, v23
    v_mfma_f32_32x32x16_bf16 v[64:79], a[56:59], v[56:59], v[64:79]
    s_waitcnt lgkmcnt(6)
    ds_read_b64_tr_b16 v[212:213], v5 offset:16696
    ds_read_b64_tr_b16 v[214:215], v5 offset:17144
    v_mfma_f32_32x32x16_bf16 v[144:159], v[228:231], v[116:119], v[144:159]
    ds_read_b64_tr_b16 v[216:217], v5 offset:16752
    ds_read_b64_tr_b16 v[218:219], v5 offset:17200
    v_exp_f32 v26, v26
    v_exp_f32 v27, v27
    v_cvt_pk_bf16_f32 v52, v24, v25
    v_mfma_f32_32x32x16_bf16 v[64:79], a[60:63], v[60:63], v[64:79]
    s_waitcnt lgkmcnt(8)
    ds_read_b64_tr_b16 v[220:221], v5 offset:16808
    v_exp_f32 v28, v28
    v_exp_f32 v29, v29
    v_cvt_pk_bf16_f32 v53, v26, v27
    v_mfma_f32_32x32x16_bf16 v[160:175], v[232:235], v[116:119], v[160:175]
    s_waitcnt lgkmcnt(7)
    ds_read_b64_tr_b16 v[222:223], v5 offset:17256
    v_mfma_f32_32x32x16_bf16 v[176:191], v[236:239], v[116:119], v[176:191]
    s_waitcnt vmcnt(12) lgkmcnt(6)
    v_exp_f32 v30, v30
    v_exp_f32 v31, v31
    v_cvt_pk_bf16_f32 v54, v28, v29
    v_mfma_f32_32x32x16_bf16 v[128:143], v[208:211], v[120:123], v[128:143]
    ds_read_b64_tr_b16 v[224:225], v5 offset:17536
    ds_read_b64_tr_b16 v[226:227], v5 offset:17984
    buffer_load_dwordx4 a[48:51], v1, s[32:35], s69 offen offset:0 sc1
    buffer_load_dwordx4 a[52:55], v1, s[32:35], s69 offen offset:1024 sc1
    v_exp_f32 v32, v32
    v_exp_f32 v33, v33
    v_cvt_pk_bf16_f32 v55, v30, v31
    v_mfma_f32_32x32x16_bf16 v[16:31], a[64:67], a[112:115], 0
    s_waitcnt lgkmcnt(6)
    ds_read_b64_tr_b16 v[228:229], v5 offset:17592
    ds_read_b64_tr_b16 v[230:231], v5 offset:18040
    v_mfma_f32_32x32x16_bf16 v[144:159], v[212:215], v[120:123], v[144:159]
    ds_read_b64_tr_b16 v[232:233], v5 offset:17648
    ds_read_b64_tr_b16 v[234:235], v5 offset:18096
    v_exp_f32 v34, v34
    v_exp_f32 v35, v35
    v_cvt_pk_bf16_f32 v56, v32, v33
    v_mfma_f32_32x32x16_bf16 v[16:31], a[68:71], a[116:119], v[16:31]
    s_waitcnt lgkmcnt(8)
    ds_read_b64_tr_b16 v[236:237], v5 offset:17704
    v_exp_f32 v36, v36
    v_exp_f32 v37, v37
    v_cvt_pk_bf16_f32 v57, v34, v35
    v_mfma_f32_32x32x16_bf16 v[160:175], v[216:219], v[120:123], v[160:175]
    s_waitcnt lgkmcnt(7)
    ds_read_b64_tr_b16 v[238:239], v5 offset:18152
    v_mfma_f32_32x32x16_bf16 v[176:191], v[220:223], v[120:123], v[176:191]
    s_waitcnt vmcnt(12) lgkmcnt(6)
    v_exp_f32 v38, v38
    v_exp_f32 v39, v39
    v_cvt_pk_bf16_f32 v58, v36, v37
    v_mfma_f32_32x32x16_bf16 v[128:143], v[224:227], v[124:127], v[128:143]
    ds_read_b64_tr_b16 v[208:209], v5 offset:18560
    ds_read_b64_tr_b16 v[210:211], v5 offset:19008
    v_exp_f32 v40, v40
    v_exp_f32 v41, v41
WPAD58:
    s_cbranch_execz WRET0
    v_cvt_pk_bf16_f32 v59, v38, v39
    v_mfma_f32_32x32x16_bf16 a[128:143], a[72:75], v[48:51], a[128:143]
    s_waitcnt lgkmcnt(6)
    ds_read_b64_tr_b16 v[212:213], v5 offset:18616
    ds_read_b64_tr_b16 v[214:215], v5 offset:19064
    v_mfma_f32_32x32x16_bf16 v[144:159], v[228:231], v[124:127], v[144:159]
    ds_read_b64_tr_b16 v[216:217], v5 offset:18672
    ds_read_b64_tr_b16 v[218:219], v5 offset:19120
    v_exp_f32 v42, v42
    v_exp_f32 v43, v43
    v_cvt_pk_bf16_f32 v60, v40, v41
    v_mfma_f32_32x32x16_bf16 a[128:143], a[76:79], v[52:55], a[128:143]
    s_waitcnt lgkmcnt(8)
    ds_read_b64_tr_b16 v[220:221], v5 offset:18728
    v_exp_f32 v44, v44
    v_exp_f32 v45, v45
    v_cvt_pk_bf16_f32 v61, v42, v43
    v_mfma_f32_32x32x16_bf16 v[160:175], v[232:235], v[124:127], v[160:175]
    s_waitcnt lgkmcnt(7)
    ds_read_b64_tr_b16 v[222:223], v5 offset:19176
    v_mfma_f32_32x32x16_bf16 v[176:191], v[236:239], v[124:127], v[176:191]
    s_waitcnt vmcnt(11) lgkmcnt(6)
    v_exp_f32 v46, v46
    v_exp_f32 v47, v47
    v_cvt_pk_bf16_f32 v62, v44, v45
    v_mfma_f32_32x32x16_bf16 v[128:143], v[208:211], v[80:83], v[128:143]
    ds_read_b64_tr_b16 v[224:225], v5 offset:19456
    ds_read_b64_tr_b16 v[226:227], v5 offset:19904
    buffer_load_dwordx4 a[56:59], v1, s[32:35], s69 offen offset:2048 sc1
    v_exp_f32 v16, v16
    v_exp_f32 v17, v17
    v_cvt_pk_bf16_f32 v63, v46, v47
    v_mfma_f32_32x32x16_bf16 v[32:47], a[64:67], a[120:123], 0
    s_waitcnt lgkmcnt(6)
    ds_read_b64_tr_b16 v[228:229], v5 offset:19512
    ds_read_b64_tr_b16 v[230:231], v5 offset:19960
    v_mfma_f32_32x32x16_bf16 v[144:159], v[212:215], v[80:83], v[144:159]
    ds_read_b64_tr_b16 v[232:233], v5 offset:19568
    ds_read_b64_tr_b16 v[234:235], v5 offset:20016
    v_exp_f32 v18, v18
    v_exp_f32 v19, v19
    v_cvt_pk_bf16_f32 v48, v16, v17
    v_mfma_f32_32x32x16_bf16 v[32:47], a[68:71], a[124:127], v[32:47]
    s_waitcnt lgkmcnt(8)
    ds_read_b64_tr_b16 v[236:237], v5 offset:19624
    v_exp_f32 v20, v20
    v_exp_f32 v21, v21
    v_cvt_pk_bf16_f32 v49, v18, v19
    v_mfma_f32_32x32x16_bf16 v[160:175], v[216:219], v[80:83], v[160:175]
    s_waitcnt lgkmcnt(7)
    ds_read_b64_tr_b16 v[238:239], v5 offset:20072
    v_mfma_f32_32x32x16_bf16 v[176:191], v[220:223], v[80:83], v[176:191]
    s_waitcnt vmcnt(9) lgkmcnt(6)
    v_exp_f32 v22, v22
    v_exp_f32 v23, v23
    v_cvt_pk_bf16_f32 v50, v20, v21
    v_mfma_f32_32x32x16_bf16 v[128:143], v[224:227], v[84:87], v[128:143]
    ds_read_b64_tr_b16 v[208:209], v5 offset:20352
    ds_read_b64_tr_b16 v[210:211], v5 offset:20800
    v_exp_f32 v24, v24
    v_exp_f32 v25, v25
    v_cvt_pk_bf16_f32 v51, v22, v23
    v_mfma_f32_32x32x16_bf16 a[144:159], a[72:75], v[56:59], a[144:159]
    s_waitcnt lgkmcnt(6)
    ds_read_b64_tr_b16 v[212:213], v5 offset:20408
    ds_read_b64_tr_b16 v[214:215], v5 offset:20856
    v_mfma_f32_32x32x16_bf16 v[144:159], v[228:231], v[84:87], v[144:159]
    ds_read_b64_tr_b16 v[216:217], v5 offset:20464
    ds_read_b64_tr_b16 v[218:219], v5 offset:20912
    v_exp_f32 v26, v26
    v_exp_f32 v27, v27
    v_cvt_pk_bf16_f32 v52, v24, v25
    v_mfma_f32_32x32x16_bf16 a[144:159], a[76:79], v[60:63], a[144:159]
    s_waitcnt lgkmcnt(8)
    ds_read_b64_tr_b16 v[220:221], v5 offset:20520
    v_exp_f32 v28, v28
    v_exp_f32_e64 v29, v29
    v_cvt_pk_bf16_f32 v53, v26, v27
WPAD59:
    s_cbranch_execz WRET0
    v_mfma_f32_32x32x16_bf16 v[160:175], v[232:235], v[84:87], v[160:175]
    s_waitcnt lgkmcnt(7)
    ds_read_b64_tr_b16 v[222:223], v5 offset:20968
    v_mfma_f32_32x32x16_bf16 v[176:191], v[236:239], v[84:87], v[176:191]
    s_waitcnt vmcnt(8) lgkmcnt(6)
    v_exp_f32 v30, v30
    v_exp_f32 v31, v31
    v_cvt_pk_bf16_f32 v54, v28, v29
    v_mfma_f32_32x32x16_bf16 v[128:143], v[208:211], v[88:91], v[128:143]
    ds_read_b64_tr_b16 v[224:225], v5 offset:21248
    ds_read_b64_tr_b16 v[226:227], v5 offset:21696
    buffer_load_dwordx4 a[60:63], v1, s[32:35], s69 offen offset:3072 sc1
    v_exp_f32 v32, v32
    v_exp_f32 v33, v33
    v_cvt_pk_bf16_f32 v55, v30, v31
    v_mfma_f32_32x32x16_bf16 v[16:31], a[80:83], a[96:99], 0
    s_waitcnt lgkmcnt(6)
    ds_read_b64_tr_b16 v[228:229], v5 offset:21304
    ds_read_b64_tr_b16 v[230:231], v5 offset:21752
    v_mfma_f32_32x32x16_bf16 v[144:159], v[212:215], v[88:91], v[144:159]
    ds_read_b64_tr_b16 v[232:233], v5 offset:21360
    ds_read_b64_tr_b16 v[234:235], v5 offset:21808
    v_exp_f32 v34, v34
    v_exp_f32 v35, v35
    v_cvt_pk_bf16_f32 v56, v32, v33
    v_mfma_f32_32x32x16_bf16 v[16:31], a[84:87], a[100:103], v[16:31]
    s_waitcnt lgkmcnt(8)
    ds_read_b64_tr_b16 v[236:237], v5 offset:21416
    v_exp_f32 v36, v36
    v_exp_f32 v37, v37
    v_cvt_pk_bf16_f32 v57, v34, v35
    v_mfma_f32_32x32x16_bf16 v[160:175], v[216:219], v[88:91], v[160:175]
    s_waitcnt lgkmcnt(7)
    ds_read_b64_tr_b16 v[238:239], v5 offset:21864
    v_mfma_f32_32x32x16_bf16 v[176:191], v[220:223], v[88:91], v[176:191]
    s_waitcnt vmcnt(7) lgkmcnt(6)
    v_exp_f32 v38, v38
    v_exp_f32 v39, v39
    v_cvt_pk_bf16_f32 v58, v36, v37
    v_mfma_f32_32x32x16_bf16 v[128:143], v[224:227], v[92:95], v[128:143]
    v_exp_f32 v40, v40
    v_exp_f32 v41, v41
    v_cvt_pk_bf16_f32 v59, v38, v39
    v_mfma_f32_32x32x16_bf16 a[160:175], a[72:75], v[48:51], a[160:175]
    s_waitcnt lgkmcnt(4)
    v_mfma_f32_32x32x16_bf16 v[144:159], v[228:231], v[92:95], v[144:159]
    v_exp_f32 v42, v42
    v_exp_f32 v43, v43
    v_cvt_pk_bf16_f32 v60, v40, v41
    v_mfma_f32_32x32x16_bf16 a[160:175], a[76:79], v[52:55], a[160:175]
    s_waitcnt lgkmcnt(2)
    v_exp_f32 v44, v44
    v_exp_f32 v45, v45
    v_cvt_pk_bf16_f32 v61, v42, v43
    v_mfma_f32_32x32x16_bf16 v[160:175], v[232:235], v[92:95], v[160:175]
    s_waitcnt lgkmcnt(0)
    v_mfma_f32_32x32x16_bf16 v[176:191], v[236:239], v[92:95], v[176:191]
    v_exp_f32 v46, v46
    v_exp_f32 v47, v47
    v_cvt_pk_bf16_f32 v62, v44, v45
    v_exp_f32 v16, v16
    v_exp_f32 v17, v17
    v_cvt_pk_bf16_f32 v63, v46, v47
    v_mfma_f32_32x32x16_bf16 v[32:47], a[80:83], a[104:107], 0
    s_barrier
    v_exp_f32 v18, v18
    v_exp_f32 v19, v19
    v_cvt_pk_bf16_f32 v48, v16, v17
    v_exp_f32 v20, v20
    v_exp_f32 v21, v21
    v_cvt_pk_bf16_f32 v49, v18, v19
    v_cvt_pk_bf16_f32 v80, v128, v129
    v_cvt_pk_bf16_f32 v81, v130, v131
    v_mfma_f32_32x32x16_bf16 v[32:47], a[84:87], a[108:111], v[32:47]
    v_exp_f32 v22, v22
    v_exp_f32 v23, v23
    v_cvt_pk_bf16_f32 v50, v20, v21
    v_cvt_pk_bf16_f32 v82, v132, v133
    v_cvt_pk_bf16_f32 v83, v134, v135
    v_exp_f32 v24, v24
    v_exp_f32_e64 v25, v25
    v_cvt_pk_bf16_f32 v51, v22, v23
WPAD60:
    s_cbranch_execz WRET0
    v_cvt_pk_bf16_f32 v84, v136, v137
    v_cvt_pk_bf16_f32 v85, v138, v139
    v_mfma_f32_32x32x16_bf16 v[64:79], a[72:75], v[56:59], v[64:79]
    v_exp_f32 v26, v26
    v_exp_f32 v27, v27
    v_cvt_pk_bf16_f32 v52, v24, v25
    v_cvt_pk_bf16_f32 v86, v140, v141
    v_cvt_pk_bf16_f32 v87, v142, v143
    v_exp_f32 v28, v28
    v_exp_f32 v29, v29
    v_cvt_pk_bf16_f32 v53, v26, v27
    v_cvt_pk_bf16_f32 v88, v144, v145
    v_cvt_pk_bf16_f32 v89, v146, v147
    v_mfma_f32_32x32x16_bf16 v[64:79], a[76:79], v[60:63], v[64:79]
    buffer_store_dwordx4 v[80:83], v1, s[32:35], s75 offen offset:0 sc1
    buffer_store_dwordx4 v[84:87], v1, s[32:35], s75 offen offset:1024 sc1
    v_exp_f32 v30, v30
    v_exp_f32 v31, v31
    v_cvt_pk_bf16_f32 v54, v28, v29
    v_cvt_pk_bf16_f32 v90, v148, v149
    v_cvt_pk_bf16_f32 v91, v150, v151
    v_exp_f32 v32, v32
    v_exp_f32 v33, v33
    v_cvt_pk_bf16_f32 v55, v30, v31
    v_cvt_pk_bf16_f32 v92, v152, v153
    v_cvt_pk_bf16_f32 v93, v154, v155
    v_mfma_f32_32x32x16_bf16 v[16:31], a[80:83], a[112:115], 0
    s_add_u32 s75, s75, 16384
    v_exp_f32 v34, v34
    v_exp_f32 v35, v35
    v_cvt_pk_bf16_f32 v56, v32, v33
    v_cvt_pk_bf16_f32 v94, v156, v157
    v_cvt_pk_bf16_f32 v95, v158, v159
    v_exp_f32 v36, v36
    v_exp_f32 v37, v37
    v_cvt_pk_bf16_f32 v57, v34, v35
    v_cvt_pk_bf16_f32 v96, v160, v161
    v_cvt_pk_bf16_f32 v97, v162, v163
    v_mfma_f32_32x32x16_bf16 v[16:31], a[84:87], a[116:119], v[16:31]
    buffer_store_dwordx4 v[88:91], v1, s[32:35], s75 offen offset:0 sc1
    buffer_store_dwordx4 v[92:95], v1, s[32:35], s75 offen offset:1024 sc1
    v_exp_f32 v38, v38
    v_exp_f32 v39, v39
    v_cvt_pk_bf16_f32 v58, v36, v37
    v_cvt_pk_bf16_f32 v98, v164, v165
    v_cvt_pk_bf16_f32 v99, v166, v167
    v_exp_f32 v40, v40
    v_exp_f32 v41, v41
    v_cvt_pk_bf16_f32 v59, v38, v39
    v_cvt_pk_bf16_f32 v100, v168, v169
    v_cvt_pk_bf16_f32 v101, v170, v171
    v_mfma_f32_32x32x16_bf16 a[128:143], a[88:91], v[48:51], a[128:143]
    s_add_u32 s75, s75, 16384
    v_exp_f32 v42, v42
    v_exp_f32 v43, v43
    v_cvt_pk_bf16_f32 v60, v40, v41
    v_cvt_pk_bf16_f32 v102, v172, v173
    v_cvt_pk_bf16_f32 v103, v174, v175
    v_exp_f32 v44, v44
    v_exp_f32 v45, v45
    v_cvt_pk_bf16_f32 v61, v42, v43
    v_cvt_pk_bf16_f32 v104, v176, v177
    v_cvt_pk_bf16_f32 v105, v178, v179
    v_mfma_f32_32x32x16_bf16 a[128:143], a[92:95], v[52:55], a[128:143]
    buffer_store_dwordx4 v[96:99], v1, s[32:35], s75 offen offset:0 sc1
    buffer_store_dwordx4 v[100:103], v1, s[32:35], s75 offen offset:1024 sc1
    v_exp_f32 v46, v46
    v_exp_f32 v47, v47
    v_cvt_pk_bf16_f32 v62, v44, v45
    v_cvt_pk_bf16_f32 v106, v180, v181
    v_cvt_pk_bf16_f32 v107, v182, v183
    v_exp_f32 v16, v16
    v_exp_f32_e64 v17, v17
    v_cvt_pk_bf16_f32 v63, v46, v47
    v_cvt_pk_bf16_f32 v108, v184, v185
WPAD61:
    s_cbranch_execz WRET0
    v_cvt_pk_bf16_f32 v109, v186, v187
    v_mfma_f32_32x32x16_bf16 v[32:47], a[80:83], a[120:123], 0
    s_add_u32 s75, s75, 16384
    v_exp_f32 v18, v18
    v_exp_f32 v19, v19
    v_cvt_pk_bf16_f32 v48, v16, v17
    v_cvt_pk_bf16_f32 v110, v188, v189
    v_cvt_pk_bf16_f32 v111, v190, v191
    v_exp_f32 v20, v20
    v_exp_f32 v21, v21
    v_cvt_pk_bf16_f32 v49, v18, v19
    v_mfma_f32_32x32x16_bf16 v[32:47], a[84:87], a[124:127], v[32:47]
    s_add_u32 m0, s45, 0
    s_nop 0
    buffer_load_dwordx4 v7, s[12:15], s65 offen offset:0 lds
    v_exp_f32 v22, v22
    v_exp_f32 v23, v23
    v_cvt_pk_bf16_f32 v50, v20, v21
    v_exp_f32 v24, v24
    v_exp_f32 v25, v25
    v_cvt_pk_bf16_f32 v51, v22, v23
    v_mfma_f32_32x32x16_bf16 a[144:159], a[88:91], v[56:59], a[144:159]
    buffer_load_dwordx4 v6, s[12:15], s65 offen offset:896 lds
    buffer_store_dwordx4 v[104:107], v1, s[32:35], s75 offen offset:0 sc1
    v_exp_f32 v26, v26
    v_exp_f32 v27, v27
    v_cvt_pk_bf16_f32 v52, v24, v25
    v_exp_f32 v28, v28
    v_exp_f32 v29, v29
    v_cvt_pk_bf16_f32 v53, v26, v27
    v_mfma_f32_32x32x16_bf16 a[144:159], a[92:95], v[60:63], a[144:159]
    buffer_store_dwordx4 v[108:111], v1, s[32:35], s75 offen offset:1024 sc1
    v_exp_f32 v30, v30
    v_exp_f32 v31, v31
    v_cvt_pk_bf16_f32 v54, v28, v29
    v_exp_f32 v32, v32
    v_exp_f32 v33, v33
    v_cvt_pk_bf16_f32 v55, v30, v31
    v_mfma_f32_32x32x16_bf16 v[16:31], a[192:195], a[96:99], 0
    v_exp_f32 v34, v34
    v_exp_f32 v35, v35
    v_cvt_pk_bf16_f32 v56, v32, v33
    v_exp_f32 v36, v36
    v_exp_f32 v37, v37
    v_cvt_pk_bf16_f32 v57, v34, v35
    v_mfma_f32_32x32x16_bf16 v[16:31], a[196:199], a[100:103], v[16:31]
    buffer_load_dwordx4 v13, s[12:15], s65 offen offset:1792 lds
    buffer_load_dwordx4 v8, s[12:15], s65 offen offset:2688 lds
    v_exp_f32 v38, v38
    v_exp_f32 v39, v39
    v_cvt_pk_bf16_f32 v58, v36, v37
    v_exp_f32 v40, v40
    v_exp_f32 v41, v41
    v_cvt_pk_bf16_f32 v59, v38, v39
    v_mfma_f32_32x32x16_bf16 a[160:175], a[88:91], v[48:51], a[160:175]
    s_add_u32 s65, s65, 57344
    v_exp_f32 v42, v42
    v_exp_f32 v43, v43
    v_cvt_pk_bf16_f32 v60, v40, v41
    v_exp_f32 v44, v44
    v_exp_f32 v45, v45
    v_cvt_pk_bf16_f32 v61, v42, v43
    v_mfma_f32_32x32x16_bf16 a[160:175], a[92:95], v[52:55], a[160:175]
    v_exp_f32 v46, v46
    v_exp_f32 v47, v47
    v_cvt_pk_bf16_f32 v62, v44, v45
    v_exp_f32 v16, v16
    v_exp_f32 v17, v17
    v_cvt_pk_bf16_f32 v63, v46, v47
    v_mfma_f32_32x32x16_bf16 v[32:47], a[192:195], a[104:107], 0
    v_exp_f32 v18, v18
    v_exp_f32 v19, v19
    v_cvt_pk_bf16_f32 v48, v16, v17
    v_exp_f32 v20, v20
    v_exp_f32 v21, v21
    v_cvt_pk_bf16_f32 v49, v18, v19
    v_mfma_f32_32x32x16_bf16 v[32:47], a[196:199], a[108:111], v[32:47]
    s_add_u32 m0, s45, 3584
    s_nop 0
    buffer_load_dwordx4 v7, s[12:15], s65 offen offset:0 lds
    v_exp_f32 v22, v22
    v_exp_f32 v23, v23
    v_cvt_pk_bf16_f32 v50, v20, v21
    v_exp_f32 v24, v24
    v_exp_f32 v25, v25
WPAD62:
    s_cbranch_execz WRET0
    v_cvt_pk_bf16_f32 v51, v22, v23
    v_mfma_f32_32x32x16_bf16 v[64:79], a[88:91], v[56:59], v[64:79]
    buffer_load_dwordx4 v6, s[12:15], s65 offen offset:896 lds
    v_exp_f32 v26, v26
    v_exp_f32 v27, v27
    v_cvt_pk_bf16_f32 v52, v24, v25
    v_exp_f32 v28, v28
    v_exp_f32 v29, v29
    v_cvt_pk_bf16_f32 v53, v26, v27
    v_mfma_f32_32x32x16_bf16 v[64:79], a[92:95], v[60:63], v[64:79]
    v_exp_f32 v30, v30
    v_exp_f32 v31, v31
    v_cvt_pk_bf16_f32 v54, v28, v29
    v_exp_f32 v32, v32
    v_exp_f32 v33, v33
    v_cvt_pk_bf16_f32 v55, v30, v31
    v_mfma_f32_32x32x16_bf16 v[16:31], a[192:195], a[112:115], 0
    v_exp_f32 v34, v34
    v_exp_f32 v35, v35
    v_cvt_pk_bf16_f32 v56, v32, v33
    v_exp_f32 v36, v36
    v_exp_f32 v37, v37
    v_cvt_pk_bf16_f32 v57, v34, v35
    v_mfma_f32_32x32x16_bf16 v[16:31], a[196:199], a[116:119], v[16:31]
    buffer_load_dwordx4 v13, s[12:15], s65 offen offset:1792 lds
    buffer_load_dwordx4 v8, s[12:15], s65 offen offset:2688 lds
    v_exp_f32 v38, v38
    v_exp_f32 v39, v39
    v_cvt_pk_bf16_f32 v58, v36, v37
    v_exp_f32 v40, v40
    v_exp_f32 v41, v41
    v_cvt_pk_bf16_f32 v59, v38, v39
    v_mfma_f32_32x32x16_bf16 a[128:143], a[200:203], v[48:51], a[128:143]
    s_add_u32 s65, s65, 57344
    v_exp_f32 v42, v42
    v_exp_f32 v43, v43
    v_cvt_pk_bf16_f32 v60, v40, v41
    v_exp_f32 v44, v44
    v_exp_f32 v45, v45
    v_cvt_pk_bf16_f32 v61, v42, v43
    v_mfma_f32_32x32x16_bf16 a[128:143], a[204:207], v[52:55], a[128:143]
    v_exp_f32 v46, v46
    v_exp_f32 v47, v47
    v_cvt_pk_bf16_f32 v62, v44, v45
    v_exp_f32 v16, v16
    v_exp_f32 v17, v17
    v_cvt_pk_bf16_f32 v63, v46, v47
    v_mfma_f32_32x32x16_bf16 v[32:47], a[192:195], a[120:123], 0
    v_exp_f32 v18, v18
    v_exp_f32 v19, v19
    v_cvt_pk_bf16_f32 v48, v16, v17
    v_exp_f32 v20, v20
    v_exp_f32 v21, v21
    v_cvt_pk_bf16_f32 v49, v18, v19
    v_mfma_f32_32x32x16_bf16 v[32:47], a[196:199], a[124:127], v[32:47]
    s_add_u32 m0, s45, 7168
    s_nop 0
    buffer_load_dwordx4 v7, s[12:15], s65 offen offset:0 lds
    v_exp_f32 v22, v22
    v_exp_f32 v23, v23
    v_cvt_pk_bf16_f32 v50, v20, v21
    v_exp_f32 v24, v24
    v_exp_f32 v25, v25
    v_cvt_pk_bf16_f32 v51, v22, v23
    v_mfma_f32_32x32x16_bf16 a[144:159], a[200:203], v[56:59], a[144:159]
    v_exp_f32 v26, v26
    v_exp_f32 v27, v27
    v_cvt_pk_bf16_f32 v52, v24, v25
    v_exp_f32 v28, v28
    v_exp_f32 v29, v29
    v_cvt_pk_bf16_f32 v53, v26, v27
    v_mfma_f32_32x32x16_bf16 a[144:159], a[204:207], v[60:63], a[144:159]
    v_exp_f32 v30, v30
    v_exp_f32 v31, v31
    v_cvt_pk_bf16_f32 v54, v28, v29
    v_exp_f32 v32, v32
    v_exp_f32 v33, v33
    v_cvt_pk_bf16_f32 v55, v30, v31
    v_mfma_f32_32x32x16_bf16 v[16:31], a[208:211], a[96:99], 0
    v_exp_f32 v34, v34
    v_exp_f32 v35, v35
    v_cvt_pk_bf16_f32 v56, v32, v33
    v_exp_f32 v36, v36
    v_exp_f32 v37, v37
    v_cvt_pk_bf16_f32 v57, v34, v35
    v_mfma_f32_32x32x16_bf16 v[16:31], a[212:215], a[100:103], v[16:31]
WPAD63:
    s_cbranch_execz WRET0
    buffer_load_dwordx4 v6, s[12:15], s65 offen offset:896 lds
    buffer_load_dwordx4 v13, s[12:15], s65 offen offset:1792 lds
    v_exp_f32 v38, v38
    v_exp_f32 v39, v39
    v_cvt_pk_bf16_f32 v58, v36, v37
    v_exp_f32 v40, v40
    v_exp_f32 v41, v41
    v_cvt_pk_bf16_f32 v59, v38, v39
    v_mfma_f32_32x32x16_bf16 a[160:175], a[200:203], v[48:51], a[160:175]
    v_exp_f32 v42, v42
    v_exp_f32 v43, v43
    v_cvt_pk_bf16_f32 v60, v40, v41
    v_exp_f32 v44, v44
    v_exp_f32 v45, v45
    v_cvt_pk_bf16_f32 v61, v42, v43
    v_mfma_f32_32x32x16_bf16 a[160:175], a[204:207], v[52:55], a[160:175]
    v_exp_f32 v46, v46
    v_exp_f32 v47, v47
    v_cvt_pk_bf16_f32 v62, v44, v45
    v_exp_f32 v16, v16
    v_exp_f32 v17, v17
    v_cvt_pk_bf16_f32 v63, v46, v47
    v_mfma_f32_32x32x16_bf16 v[32:47], a[208:211], a[104:107], 0
    v_exp_f32 v18, v18
    v_exp_f32 v19, v19
    v_cvt_pk_bf16_f32 v48, v16, v17
    v_exp_f32 v20, v20
    v_exp_f32 v21, v21
    v_cvt_pk_bf16_f32 v49, v18, v19
    v_mfma_f32_32x32x16_bf16 v[32:47], a[212:215], a[108:111], v[32:47]
    buffer_load_dwordx4 v8, s[12:15], s65 offen offset:2688 lds
    s_add_u32 s65, s65, 57344
    v_exp_f32 v22, v22
    v_exp_f32 v23, v23
    v_cvt_pk_bf16_f32 v50, v20, v21
    v_exp_f32 v24, v24
    v_exp_f32 v25, v25
    v_cvt_pk_bf16_f32 v51, v22, v23
    v_mfma_f32_32x32x16_bf16 v[64:79], a[200:203], v[56:59], v[64:79]
    s_add_u32 m0, s45, 10752
    s_nop 0
    buffer_load_dwordx4 v7, s[12:15], s65 offen offset:0 lds
    v_exp_f32 v26, v26
    v_exp_f32 v27, v27
    v_cvt_pk_bf16_f32 v52, v24, v25
    v_exp_f32 v28, v28
    v_exp_f32 v29, v29
    v_cvt_pk_bf16_f32 v53, v26, v27
    v_mfma_f32_32x32x16_bf16 v[64:79], a[204:207], v[60:63], v[64:79]
    v_exp_f32 v30, v30
    v_exp_f32 v31, v31
    v_cvt_pk_bf16_f32 v54, v28, v29
    v_exp_f32 v32, v32
    v_exp_f32 v33, v33
    v_cvt_pk_bf16_f32 v55, v30, v31
    v_mfma_f32_32x32x16_bf16 v[16:31], a[208:211], a[112:115], 0
    v_exp_f32 v34, v34
    v_exp_f32 v35, v35
    v_cvt_pk_bf16_f32 v56, v32, v33
    v_exp_f32 v36, v36
    v_exp_f32 v37, v37
    v_cvt_pk_bf16_f32 v57, v34, v35
    v_mfma_f32_32x32x16_bf16 v[16:31], a[212:215], a[116:119], v[16:31]
    buffer_load_dwordx4 v6, s[12:15], s65 offen offset:896 lds
    buffer_load_dwordx4 v13, s[12:15], s65 offen offset:1792 lds
    v_exp_f32 v38, v38
    v_exp_f32 v39, v39
    v_cvt_pk_bf16_f32 v58, v36, v37
    v_exp_f32 v40, v40
    v_exp_f32 v41, v41
    v_cvt_pk_bf16_f32 v59, v38, v39
    v_mfma_f32_32x32x16_bf16 a[128:143], a[216:219], v[48:51], a[128:143]
    v_exp_f32 v42, v42
    v_exp_f32 v43, v43
    v_cvt_pk_bf16_f32 v60, v40, v41
    v_exp_f32 v44, v44
    v_exp_f32 v45, v45
    v_cvt_pk_bf16_f32 v61, v42, v43
    v_mfma_f32_32x32x16_bf16 a[128:143], a[220:223], v[52:55], a[128:143]
    v_exp_f32 v46, v46
    v_exp_f32 v47, v47
    v_cvt_pk_bf16_f32 v62, v44, v45
    v_exp_f32 v16, v16
    v_exp_f32 v17, v17
    v_cvt_pk_bf16_f32 v63, v46, v47
    v_mfma_f32_32x32x16_bf16 v[32:47], a[208:211], a[120:123], 0
WPAD64:
    s_cbranch_execz WRET0
    v_exp_f32 v18, v18
    v_exp_f32 v19, v19
    v_cvt_pk_bf16_f32 v48, v16, v17
    v_exp_f32 v20, v20
    v_exp_f32 v21, v21
    v_cvt_pk_bf16_f32 v49, v18, v19
    v_mfma_f32_32x32x16_bf16 v[32:47], a[212:215], a[124:127], v[32:47]
    buffer_load_dwordx4 v8, s[12:15], s65 offen offset:2688 lds
    s_add_u32 s65, s65, 57344
    v_exp_f32 v22, v22
    v_exp_f32 v23, v23
    v_cvt_pk_bf16_f32 v50, v20, v21
    v_exp_f32 v24, v24
    v_exp_f32 v25, v25
    v_cvt_pk_bf16_f32 v51, v22, v23
    v_mfma_f32_32x32x16_bf16 a[144:159], a[216:219], v[56:59], a[144:159]
    s_add_u32 m0, s45, 14336
    s_nop 0
    buffer_load_dwordx4 v7, s[12:15], s65 offen offset:0 lds
    v_exp_f32 v26, v26
    v_exp_f32 v27, v27
    v_cvt_pk_bf16_f32 v52, v24, v25
    v_exp_f32 v28, v28
    v_exp_f32 v29, v29
    v_cvt_pk_bf16_f32 v53, v26, v27
    v_mfma_f32_32x32x16_bf16 a[144:159], a[220:223], v[60:63], a[144:159]
    v_exp_f32 v30, v30
    v_exp_f32 v31, v31
    v_cvt_pk_bf16_f32 v54, v28, v29
    v_exp_f32 v32, v32
    v_exp_f32 v33, v33
    v_cvt_pk_bf16_f32 v55, v30, v31
    v_mfma_f32_32x32x16_bf16 v[16:31], a[224:227], a[96:99], 0
    v_exp_f32 v34, v34
    v_exp_f32 v35, v35
    v_cvt_pk_bf16_f32 v56, v32, v33
    v_exp_f32 v36, v36
    v_exp_f32 v37, v37
    v_cvt_pk_bf16_f32 v57, v34, v35
    v_mfma_f32_32x32x16_bf16 v[16:31], a[228:231], a[100:103], v[16:31]
    buffer_load_dwordx4 v6, s[12:15], s65 offen offset:896 lds
    v_exp_f32 v38, v38
    v_exp_f32 v39, v39
    v_cvt_pk_bf16_f32 v58, v36, v37
    v_exp_f32 v40, v40
    v_exp_f32 v41, v41
    v_cvt_pk_bf16_f32 v59, v38, v39
    v_mfma_f32_32x32x16_bf16 a[160:175], a[216:219], v[48:51], a[160:175]
    v_exp_f32 v42, v42
    v_exp_f32 v43, v43
    v_cvt_pk_bf16_f32 v60, v40, v41
    v_exp_f32 v44, v44
    v_exp_f32 v45, v45
    v_cvt_pk_bf16_f32 v61, v42, v43
    v_mfma_f32_32x32x16_bf16 a[160:175], a[220:223], v[52:55], a[160:175]
    v_exp_f32 v46, v46
    v_exp_f32 v47, v47
    v_cvt_pk_bf16_f32 v62, v44, v45
    v_exp_f32 v16, v16
    v_exp_f32 v17, v17
    v_cvt_pk_bf16_f32 v63, v46, v47
    v_mfma_f32_32x32x16_bf16 v[32:47], a[224:227], a[104:107], 0
    v_exp_f32 v18, v18
    v_exp_f32 v19, v19
    v_cvt_pk_bf16_f32 v48, v16, v17
    v_exp_f32 v20, v20
    v_exp_f32 v21, v21
    v_cvt_pk_bf16_f32 v49, v18, v19
    v_mfma_f32_32x32x16_bf16 v[32:47], a[228:231], a[108:111], v[32:47]
    buffer_load_dwordx4 v13, s[12:15], s65 offen offset:1792 lds
    buffer_load_dwordx4 v8, s[12:15], s65 offen offset:2688 lds
    v_exp_f32 v22, v22
    v_exp_f32 v23, v23
    v_cvt_pk_bf16_f32 v50, v20, v21
    v_exp_f32 v24, v24
    v_exp_f32 v25, v25
    v_cvt_pk_bf16_f32 v51, v22, v23
    v_mfma_f32_32x32x16_bf16 v[64:79], a[216:219], v[56:59], v[64:79]
    s_add_u32 s65, s65, 57344
    v_exp_f32 v26, v26
    v_exp_f32 v27, v27
    v_cvt_pk_bf16_f32 v52, v24, v25
    v_exp_f32 v28, v28
    v_exp_f32 v29, v29
    v_cvt_pk_bf16_f32 v53, v26, v27
    v_mfma_f32_32x32x16_bf16 v[64:79], a[220:223], v[60:63], v[64:79]
WPAD65:
    s_cbranch_execz WRET0
    v_exp_f32 v30, v30
    v_exp_f32 v31, v31
    v_cvt_pk_bf16_f32 v54, v28, v29
    v_exp_f32 v32, v32
    v_exp_f32 v33, v33
    v_cvt_pk_bf16_f32 v55, v30, v31
    v_mfma_f32_32x32x16_bf16 v[16:31], a[224:227], a[112:115], 0
    v_exp_f32 v34, v34
    v_exp_f32 v35, v35
    v_cvt_pk_bf16_f32 v56, v32, v33
    v_exp_f32 v36, v36
    v_exp_f32 v37, v37
    v_cvt_pk_bf16_f32 v57, v34, v35
    v_mfma_f32_32x32x16_bf16 v[16:31], a[228:231], a[116:119], v[16:31]
    s_add_u32 m0, s45, 17920
    s_nop 0
    buffer_load_dwordx4 v7, s[12:15], s65 offen offset:0 lds
    v_exp_f32 v38, v38
    v_exp_f32 v39, v39
    v_cvt_pk_bf16_f32 v58, v36, v37
    v_exp_f32 v40, v40
    v_exp_f32 v41, v41
    v_cvt_pk_bf16_f32 v59, v38, v39
    v_mfma_f32_32x32x16_bf16 a[128:143], a[232:235], v[48:51], a[128:143]
    buffer_load_dwordx4 v6, s[12:15], s65 offen offset:896 lds
    v_exp_f32 v42, v42
    v_exp_f32 v43, v43
    v_cvt_pk_bf16_f32 v60, v40, v41
    v_exp_f32 v44, v44
    v_exp_f32 v45, v45
    v_cvt_pk_bf16_f32 v61, v42, v43
    v_mfma_f32_32x32x16_bf16 a[128:143], a[236:239], v[52:55], a[128:143]
    v_exp_f32 v46, v46
    v_exp_f32 v47, v47
    v_cvt_pk_bf16_f32 v62, v44, v45
    v_exp_f32 v16, v16
    v_exp_f32 v17, v17
    v_cvt_pk_bf16_f32 v63, v46, v47
    v_mfma_f32_32x32x16_bf16 v[32:47], a[224:227], a[120:123], 0
    v_exp_f32 v18, v18
    v_exp_f32 v19, v19
    v_cvt_pk_bf16_f32 v48, v16, v17
    v_exp_f32 v20, v20
    v_exp_f32 v21, v21
    v_cvt_pk_bf16_f32 v49, v18, v19
    v_mfma_f32_32x32x16_bf16 v[32:47], a[228:231], a[124:127], v[32:47]
    buffer_load_dwordx4 v13, s[12:15], s65 offen offset:1792 lds
    buffer_load_dwordx4 v8, s[12:15], s65 offen offset:2688 lds
    v_exp_f32 v22, v22
    v_exp_f32 v23, v23
    v_cvt_pk_bf16_f32 v50, v20, v21
    v_exp_f32 v24, v24
    v_exp_f32 v25, v25
    v_cvt_pk_bf16_f32 v51, v22, v23
    v_mfma_f32_32x32x16_bf16 a[144:159], a[232:235], v[56:59], a[144:159]
    s_add_u32 s65, s65, 57344
    v_exp_f32 v26, v26
    v_exp_f32 v27, v27
    v_cvt_pk_bf16_f32 v52, v24, v25
    v_exp_f32 v28, v28
    v_exp_f32 v29, v29
    v_cvt_pk_bf16_f32 v53, v26, v27
    v_mfma_f32_32x32x16_bf16 a[144:159], a[236:239], v[60:63], a[144:159]
    v_exp_f32 v30, v30
    v_exp_f32 v31, v31
    v_cvt_pk_bf16_f32 v54, v28, v29
    v_exp_f32 v32, v32
    v_exp_f32 v33, v33
    v_cvt_pk_bf16_f32 v55, v30, v31
    v_mfma_f32_32x32x16_bf16 v[16:31], a[32:35], a[96:99], 0
    s_waitcnt vmcnt(38)
    v_exp_f32 v34, v34
    v_exp_f32 v35, v35
    v_cvt_pk_bf16_f32 v56, v32, v33
    v_exp_f32 v36, v36
    v_exp_f32 v37, v37
    v_cvt_pk_bf16_f32 v57, v34, v35
    v_mfma_f32_32x32x16_bf16 v[16:31], a[36:39], a[100:103], v[16:31]
    s_add_u32 m0, s45, 21504
    s_nop 0
    buffer_load_dwordx4 v7, s[12:15], s65 offen offset:0 lds
    v_exp_f32 v38, v38
    v_exp_f32 v39, v39
    v_cvt_pk_bf16_f32 v58, v36, v37
    v_exp_f32 v40, v40
    v_exp_f32 v41, v41
    v_cvt_pk_bf16_f32 v59, v38, v39
WPAD66:
    s_cbranch_execz WRET0
    v_mfma_f32_32x32x16_bf16 a[160:175], a[232:235], v[48:51], a[160:175]
    buffer_load_dwordx4 v6, s[12:15], s65 offen offset:896 lds
    s_waitcnt vmcnt(24)
    v_exp_f32 v42, v42
    v_exp_f32 v43, v43
    v_cvt_pk_bf16_f32 v60, v40, v41
    v_exp_f32 v44, v44
    v_exp_f32 v45, v45
    v_cvt_pk_bf16_f32 v61, v42, v43
    v_mfma_f32_32x32x16_bf16 a[160:175], a[236:239], v[52:55], a[160:175]
    buffer_store_dword v12, v11, s[32:35], s76 offen sc1
    v_exp_f32 v46, v46
    v_exp_f32 v47, v47
    v_cvt_pk_bf16_f32 v62, v44, v45
    v_exp_f32 v16, v16
    v_exp_f32 v17, v17
    v_cvt_pk_bf16_f32 v63, v46, v47
    v_mfma_f32_32x32x16_bf16 v[32:47], a[32:35], a[104:107], 0
    v_exp_f32 v18, v18
    v_exp_f32 v19, v19
    v_cvt_pk_bf16_f32 v48, v16, v17
    v_exp_f32 v20, v20
    v_exp_f32 v21, v21
    v_cvt_pk_bf16_f32 v49, v18, v19
    v_mfma_f32_32x32x16_bf16 v[32:47], a[36:39], a[108:111], v[32:47]
    buffer_load_dwordx4 v13, s[12:15], s65 offen offset:1792 lds
    v_exp_f32 v22, v22
    v_exp_f32 v23, v23
    v_cvt_pk_bf16_f32 v50, v20, v21
    v_exp_f32 v24, v24
    v_exp_f32 v25, v25
    v_cvt_pk_bf16_f32 v51, v22, v23
    v_mfma_f32_32x32x16_bf16 v[64:79], a[232:235], v[56:59], v[64:79]
    v_exp_f32 v26, v26
    v_exp_f32 v27, v27
    v_cvt_pk_bf16_f32 v52, v24, v25
    v_exp_f32 v28, v28
    v_exp_f32 v29, v29
    v_cvt_pk_bf16_f32 v53, v26, v27
    v_mfma_f32_32x32x16_bf16 v[64:79], a[236:239], v[60:63], v[64:79]
    v_exp_f32 v30, v30
    v_exp_f32 v31, v31
    v_cvt_pk_bf16_f32 v54, v28, v29
    v_exp_f32 v32, v32
    v_exp_f32 v33, v33
    v_cvt_pk_bf16_f32 v55, v30, v31
    v_mfma_f32_32x32x16_bf16 v[16:31], a[32:35], a[112:115], 0
    v_exp_f32 v34, v34
    v_exp_f32 v35, v35
    v_cvt_pk_bf16_f32 v56, v32, v33
    v_exp_f32 v36, v36
    v_exp_f32 v37, v37
    v_cvt_pk_bf16_f32 v57, v34, v35
    v_mfma_f32_32x32x16_bf16 v[16:31], a[36:39], a[116:119], v[16:31]
    buffer_load_dwordx4 v8, s[12:15], s65 offen offset:2688 lds
    v_exp_f32 v38, v38
    v_exp_f32 v39, v39
    v_cvt_pk_bf16_f32 v58, v36, v37
    v_exp_f32 v40, v40
    v_exp_f32 v41, v41
    v_cvt_pk_bf16_f32 v59, v38, v39
    v_mfma_f32_32x32x16_bf16 a[128:143], a[40:43], v[48:51], a[128:143]
    v_exp_f32 v42, v42
    v_exp_f32 v43, v43
    v_cvt_pk_bf16_f32 v60, v40, v41
    v_exp_f32 v44, v44
    v_exp_f32 v45, v45
    v_cvt_pk_bf16_f32 v61, v42, v43
    v_mfma_f32_32x32x16_bf16 a[128:143], a[44:47], v[52:55], a[128:143]
    v_exp_f32 v46, v46
    v_exp_f32 v47, v47
    v_cvt_pk_bf16_f32 v62, v44, v45
    v_accvgpr_read_b32 v200, a254
    v_accvgpr_read_b32 v201, a255
    v_exp_f32 v16, v16
    v_exp_f32 v17, v17
    v_cvt_pk_bf16_f32 v63, v46, v47
    v_mfma_f32_32x32x16_bf16 v[32:47], a[32:35], a[120:123], 0
    buffer_load_dwordx2 v[192:193], v200, s[4:7], 0 offen offset:0
    buffer_load_dwordx2 v[194:195], v200, s[4:7], 0 offen offset:16
    v_exp_f32 v18, v18
    v_exp_f32 v19, v19
    v_cvt_pk_bf16_f32 v48, v16, v17
    v_exp_f32 v20, v20
    v_exp_f32 v21, v21
    v_cvt_pk_bf16_f32 v49, v18, v19
WPAD67:
    s_cbranch_execz WRET0
    v_mfma_f32_32x32x16_bf16 v[32:47], a[36:39], a[124:127], v[32:47]
    buffer_load_dwordx2 v[196:197], v200, s[4:7], 0 offen offset:32
    buffer_load_dwordx2 v[198:199], v200, s[4:7], 0 offen offset:48
    v_exp_f32 v22, v22
    v_exp_f32 v23, v23
    v_cvt_pk_bf16_f32 v50, v20, v21
    v_exp_f32 v24, v24
    v_exp_f32 v25, v25
    v_cvt_pk_bf16_f32 v51, v22, v23
    v_mfma_f32_32x32x16_bf16 a[144:159], a[40:43], v[56:59], a[144:159]
    v_exp_f32 v26, v26
    v_exp_f32 v27, v27
    v_cvt_pk_bf16_f32 v52, v24, v25
    v_exp_f32 v28, v28
    v_exp_f32 v29, v29
    v_cvt_pk_bf16_f32 v53, v26, v27
    v_mfma_f32_32x32x16_bf16 a[144:159], a[44:47], v[60:63], a[144:159]
    v_exp_f32 v30, v30
    v_exp_f32 v31, v31
    v_cvt_pk_bf16_f32 v54, v28, v29
    v_exp_f32 v32, v32
    v_exp_f32 v33, v33
    v_cvt_pk_bf16_f32 v55, v30, v31
    v_mfma_f32_32x32x16_bf16 v[16:31], a[48:51], a[96:99], 0
    v_exp_f32 v34, v34
    v_exp_f32 v35, v35
    v_cvt_pk_bf16_f32 v56, v32, v33
    v_exp_f32 v36, v36
    v_exp_f32 v37, v37
    v_cvt_pk_bf16_f32 v57, v34, v35
    v_mfma_f32_32x32x16_bf16 v[16:31], a[52:55], a[100:103], v[16:31]
    v_exp_f32 v38, v38
    v_exp_f32 v39, v39
    v_cvt_pk_bf16_f32 v58, v36, v37
    v_exp_f32 v40, v40
    v_exp_f32 v41, v41
    v_cvt_pk_bf16_f32 v59, v38, v39
    v_mfma_f32_32x32x16_bf16 a[160:175], a[40:43], v[48:51], a[160:175]
    v_exp_f32 v42, v42
    v_exp_f32 v43, v43
    v_cvt_pk_bf16_f32 v60, v40, v41
    v_exp_f32 v44, v44
    v_exp_f32 v45, v45
    v_cvt_pk_bf16_f32 v61, v42, v43
    v_mfma_f32_32x32x16_bf16 a[160:175], a[44:47], v[52:55], a[160:175]
    v_exp_f32 v46, v46
    v_exp_f32 v47, v47
    v_cvt_pk_bf16_f32 v62, v44, v45
    v_exp_f32 v16, v16
    v_exp_f32 v17, v17
    v_cvt_pk_bf16_f32 v63, v46, v47
    v_mfma_f32_32x32x16_bf16 v[32:47], a[48:51], a[104:107], 0
    buffer_load_dword v246, v9, s[32:35], s77 offen sc1
    v_exp_f32 v18, v18
    v_exp_f32 v19, v19
    v_cvt_pk_bf16_f32 v48, v16, v17
    v_exp_f32 v20, v20
    v_exp_f32 v21, v21
    v_cvt_pk_bf16_f32 v49, v18, v19
    v_mfma_f32_32x32x16_bf16 v[32:47], a[52:55], a[108:111], v[32:47]
    v_exp_f32 v22, v22
    v_exp_f32 v23, v23
    v_cvt_pk_bf16_f32 v50, v20, v21
    v_exp_f32 v24, v24
    v_exp_f32 v25, v25
    v_cvt_pk_bf16_f32 v51, v22, v23
    v_mfma_f32_32x32x16_bf16 v[64:79], a[40:43], v[56:59], v[64:79]
    v_exp_f32 v26, v26
    v_exp_f32 v27, v27
    v_cvt_pk_bf16_f32 v52, v24, v25
    v_exp_f32 v28, v28
    v_exp_f32 v29, v29
    v_cvt_pk_bf16_f32 v53, v26, v27
    v_mfma_f32_32x32x16_bf16 v[64:79], a[44:47], v[60:63], v[64:79]
    v_exp_f32 v30, v30
    v_exp_f32 v31, v31
    v_cvt_pk_bf16_f32 v54, v28, v29
    v_exp_f32 v32, v32
    v_exp_f32 v33, v33
    v_cvt_pk_bf16_f32 v55, v30, v31
    v_mfma_f32_32x32x16_bf16 v[16:31], a[48:51], a[112:115], 0
    v_exp_f32 v34, v34
    v_exp_f32 v35, v35
    v_cvt_pk_bf16_f32 v56, v32, v33
    v_exp_f32 v36, v36
    v_exp_f32_e64 v37, v37
    v_cvt_pk_bf16_f32 v57, v34, v35
WPAD68:
    s_cbranch_execz WRET0
    v_mfma_f32_32x32x16_bf16 v[16:31], a[52:55], a[116:119], v[16:31]
    v_exp_f32 v38, v38
    v_exp_f32 v39, v39
    v_cvt_pk_bf16_f32 v58, v36, v37
    v_exp_f32 v40, v40
    v_exp_f32 v41, v41
    v_cvt_pk_bf16_f32 v59, v38, v39
    v_mfma_f32_32x32x16_bf16 a[128:143], a[56:59], v[48:51], a[128:143]
    v_exp_f32 v42, v42
    v_exp_f32 v43, v43
    v_cvt_pk_bf16_f32 v60, v40, v41
    v_exp_f32 v44, v44
    v_exp_f32 v45, v45
    v_cvt_pk_bf16_f32 v61, v42, v43
    v_mfma_f32_32x32x16_bf16 a[128:143], a[60:63], v[52:55], a[128:143]
    v_exp_f32 v46, v46
    v_exp_f32 v47, v47
    v_cvt_pk_bf16_f32 v62, v44, v45
    v_exp_f32 v16, v16
    v_exp_f32 v17, v17
    v_cvt_pk_bf16_f32 v63, v46, v47
    v_mfma_f32_32x32x16_bf16 v[32:47], a[48:51], a[120:123], 0
    s_nop 4
    ds_write_b128 v2, a[128:131] offset:25600
    ds_write_b128 v2, a[132:135] offset:26624
    v_exp_f32 v18, v18
    v_exp_f32 v19, v19
    v_cvt_pk_bf16_f32 v48, v16, v17
    v_exp_f32 v20, v20
    v_exp_f32 v21, v21
    v_cvt_pk_bf16_f32 v49, v18, v19
    v_mfma_f32_32x32x16_bf16 v[32:47], a[52:55], a[124:127], v[32:47]
    ds_write_b128 v2, a[136:139] offset:27648
    ds_write_b128 v2, a[140:143] offset:28672
    v_exp_f32 v22, v22
    v_exp_f32 v23, v23
    v_cvt_pk_bf16_f32 v50, v20, v21
    v_exp_f32 v24, v24
    v_exp_f32 v25, v25
    v_cvt_pk_bf16_f32 v51, v22, v23
    v_mfma_f32_32x32x16_bf16 a[144:159], a[56:59], v[56:59], a[144:159]
    v_exp_f32 v26, v26
    v_exp_f32 v27, v27
    v_cvt_pk_bf16_f32 v52, v24, v25
    v_exp_f32 v28, v28
    v_exp_f32 v29, v29
    v_cvt_pk_bf16_f32 v53, v26, v27
    v_mfma_f32_32x32x16_bf16 a[144:159], a[60:63], v[60:63], a[144:159]
    v_exp_f32 v30, v30
    v_exp_f32 v31, v31
    v_cvt_pk_bf16_f32 v54, v28, v29
    v_exp_f32 v32, v32
    v_exp_f32 v33, v33
    v_cvt_pk_bf16_f32 v55, v30, v31
    v_exp_f32 v34, v34
    v_exp_f32 v35, v35
    v_cvt_pk_bf16_f32 v56, v32, v33
    v_exp_f32 v36, v36
    v_exp_f32 v37, v37
    v_cvt_pk_bf16_f32 v57, v34, v35
    v_exp_f32 v38, v38
    v_exp_f32 v39, v39
    v_cvt_pk_bf16_f32 v58, v36, v37
    v_exp_f32 v40, v40
    v_exp_f32 v41, v41
    v_cvt_pk_bf16_f32 v59, v38, v39
    v_mfma_f32_32x32x16_bf16 a[160:175], a[56:59], v[48:51], a[160:175]
    ds_write_b128 v3, a[144:147] offset:29696
    ds_write_b128 v3, a[148:151] offset:30720
    v_exp_f32 v42, v42
    v_exp_f32 v43, v43
    v_cvt_pk_bf16_f32 v60, v40, v41
    v_exp_f32 v44, v44
    v_exp_f32 v45, v45
    v_cvt_pk_bf16_f32 v61, v42, v43
    v_mfma_f32_32x32x16_bf16 a[160:175], a[60:63], v[52:55], a[160:175]
    ds_write_b128 v3, a[152:155] offset:31744
    ds_write_b128 v3, a[156:159] offset:32768
    v_exp_f32 v46, v46
    v_exp_f32_e64 v47, v47
    v_cvt_pk_bf16_f32 v62, v44, v45
    v_mfma_f32_32x32x16_bf16 v[64:79], a[56:59], v[56:59], v[64:79]
    v_cvt_pk_bf16_f32 v63, v46, v47
    s_mov_b32 s90, 0x3ef5fdf0
    s_nop 0
WPAD69:
    s_cbranch_execz WRET0
    v_mfma_f32_32x32x16_bf16 v[64:79], a[60:63], v[60:63], v[64:79]
    s_nop 1
    ds_write_b128 v4, a[160:163] offset:33792
    ds_write_b128 v4, a[164:167] offset:34816
    ds_write_b128 v4, a[168:171] offset:35840
    ds_write_b128 v4, a[172:175] offset:36864
    s_waitcnt vmcnt(5) lgkmcnt(0)
    s_barrier
    ds_read_b128 v[92:95], v10 offset:28672
    ds_read_b128 v[108:111], v10 offset:32768
    ds_read_b128 v[124:127], v10 offset:36864
    ds_read_b128 v[80:83], v10 offset:25600
    ds_read_b128 v[96:99], v10 offset:29696
    ds_read_b128 v[112:115], v10 offset:33792
    ds_read_b128 v[84:87], v10 offset:26624
    ds_read_b128 v[100:103], v10 offset:30720
    ds_read_b128 v[116:119], v10 offset:34816
    ds_read_b128 v[88:91], v10 offset:27648
    ds_read_b128 v[104:107], v10 offset:31744
    ds_read_b128 v[120:123], v10 offset:35840
    s_waitcnt lgkmcnt(11)
    v_add_f32 v76, v76, v92
    v_add_f32 v77, v77, v93
    v_add_f32 v78, v78, v94
    v_add_f32 v79, v79, v95
    s_waitcnt lgkmcnt(10)
    v_add_f32 v76, v76, v108
    v_add_f32 v77, v77, v109
    v_add_f32 v78, v78, v110
    v_add_f32 v79, v79, v111
    s_waitcnt lgkmcnt(9)
    v_add_f32 v76, v76, v124
    v_add_f32 v77, v77, v125
    v_add_f32 v78, v78, v126
    v_add_f32 v79, v79, v127
    v_mov_b32 v16, v76
    v_mov_b32 v17, v76
    s_waitcnt lgkmcnt(8)
    v_add_f32 v64, v64, v80
    v_add_f32 v65, v65, v81
    v_add_f32 v66, v66, v82
    v_add_f32 v67, v67, v83
    s_waitcnt lgkmcnt(7)
    v_add_f32 v64, v64, v96
    v_add_f32 v65, v65, v97
    v_add_f32 v66, v66, v98
    v_add_f32 v67, v67, v99
    s_waitcnt lgkmcnt(6)
    v_add_f32 v64, v64, v112
    v_add_f32 v65, v65, v113
    v_add_f32 v66, v66, v114
    v_add_f32 v67, v67, v115
    v_permlane32_swap_b32 v16, v17
    s_waitcnt lgkmcnt(5)
    v_add_f32 v68, v68, v84
    v_add_f32 v69, v69, v85
    v_add_f32 v70, v70, v86
    v_add_f32 v71, v71, v87
    s_waitcnt lgkmcnt(4)
    v_add_f32 v68, v68, v100
    v_add_f32 v69, v69, v101
    v_add_f32 v70, v70, v102
    v_add_f32 v71, v71, v103
    s_waitcnt lgkmcnt(3)
    v_add_f32 v68, v68, v116
    v_add_f32 v69, v69, v117
    v_add_f32 v70, v70, v118
    v_add_f32 v71, v71, v119
    s_mov_b32 s91, 0x1e000000
    v_subrev_u32 v18, 0x30800000, v17
    s_waitcnt lgkmcnt(2)
    v_add_f32 v72, v72, v88
    v_add_f32 v73, v73, v89
    v_add_f32 v74, v74, v90
    v_add_f32 v75, v75, v91
    s_waitcnt lgkmcnt(1)
    v_add_f32 v72, v72, v104
    v_add_f32 v73, v73, v105
    v_add_f32 v74, v74, v106
    v_add_f32 v75, v75, v107
    s_waitcnt lgkmcnt(0)
    v_add_f32 v72, v72, v120
    v_add_f32 v73, v73, v121
    v_add_f32 v74, v74, v122
    v_add_f32 v75, v75, v123
    v_cmp_lt_u32 vcc, s91, v18
    s_cbranch_vccnz FB
FB_RET:
    v_rcp_f32 v17, v17
    s_nop 0
    v_mul_f32 v17, s90, v17
    v_mul_f32 v64, v17, v64
    v_mul_f32 v65, v17, v65
    v_cvt_pk_bf16_f32 v48, v64, v65
    v_mul_f32 v66, v17, v66
    v_mul_f32 v67, v17, v67
    v_cvt_pk_bf16_f32 v49, v66, v67
    v_mul_f32 v68, v17, v68
    v_mul_f32 v69, v17, v69
    v_cvt_pk_bf16_f32 v50, v68, v69
    v_mul_f32 v70, v17, v70
    v_mul_f32 v71, v17, v71
    v_cvt_pk_bf16_f32 v51, v70, v71
    buffer_store_dwordx4 v[48:51], v1, s[32:35], s79 offen offset:0 sc1
WPAD70:
    s_cbranch_execz WRET0
    v_mul_f32 v72, v17, v72
    v_mul_f32 v73, v17, v73
    v_cvt_pk_bf16_f32 v52, v72, v73
    v_mul_f32 v74, v17, v74
    v_mul_f32 v75, v17, v75
    v_cvt_pk_bf16_f32 v53, v74, v75
    v_mul_f32 v76, v17, v76
    v_mul_f32 v77, v17, v77
    v_cvt_pk_bf16_f32 v54, v76, v77
    v_mul_f32 v78, v17, v78
    v_mul_f32 v79, v17, v79
    v_cvt_pk_bf16_f32 v55, v78, v79
    v_cndmask_b32 v54, v54, 0, s[94:95]
    v_cndmask_b32 v55, v55, 0, s[94:95]
    buffer_store_dwordx4 v[52:55], v1, s[32:35], s79 offen offset:1024 sc1
    s_waitcnt vmcnt(2)
    v_cmp_ne_u32 vcc, s46, v246
    s_cbranch_vccnz SPIN_P
RET_P:
    buffer_load_dwordx4 v[160:163], v1, s[32:35], s78 offen offset:0 sc1
    buffer_load_dwordx4 v[164:167], v1, s[32:35], s78 offen offset:1024 sc1
    s_add_u32 s78, s78, 4096
    buffer_load_dwordx4 v[168:171], v1, s[32:35], s78 offen offset:0 sc1
    buffer_load_dwordx4 v[172:175], v1, s[32:35], s78 offen offset:1024 sc1
    s_add_u32 s78, s78, 4096
    buffer_load_dwordx4 v[176:179], v1, s[32:35], s78 offen offset:0 sc1
    buffer_load_dwordx4 v[180:183], v1, s[32:35], s78 offen offset:1024 sc1
    s_add_u32 s78, s78, 4096
    buffer_load_dwordx4 v[184:187], v1, s[32:35], s78 offen offset:0 sc1
    buffer_load_dwordx4 v[188:191], v1, s[32:35], s78 offen offset:1024 sc1
    s_mul_i32 s86, s40, 56
    s_add_u32 s85, s40, 0
    s_and_b32 s85, s85, 3
    s_mul_i32 s85, s85, 6272
    s_add_u32 s85, s85, s86
    v_add_u32 v20, s85, v5
    s_add_u32 s85, s40, 1
    s_and_b32 s85, s85, 3
    s_mul_i32 s85, s85, 6272
    s_add_u32 s85, s85, s86
    v_add_u32 v21, s85, v5
    s_add_u32 s85, s40, 2
    s_and_b32 s85, s85, 3
    s_mul_i32 s85, s85, 6272
    s_add_u32 s85, s85, s86
    v_add_u32 v22, s85, v5
    s_add_u32 s85, s40, 3
    s_and_b32 s85, s85, 3
    s_mul_i32 s85, s85, 6272
    s_add_u32 s85, s85, s86
    v_add_u32 v23, s85, v5
    s_or_b32 s85, s2, s40
    s_cmp_eq_u32 s85, 0
    s_cselect_b32 s85, 0, 0x80000000
    v_or_b32 v206, s85, v11
    v_lshlrev_b32 v207, 8, v9
    s_mov_b32 s87, 0x3f80
    s_mov_b32 s88, 0x3f800000
    ds_read_b64_tr_b16 a[0:1], v20 offset:0
    ds_read_b64_tr_b16 a[2:3], v20 offset:448
    ds_read_b64_tr_b16 a[4:5], v20 offset:896
    ds_read_b64_tr_b16 a[6:7], v20 offset:1344
    ds_read_b64_tr_b16 a[8:9], v20 offset:1568
    ds_read_b64_tr_b16 a[10:11], v20 offset:2016
    ds_read_b64_tr_b16 a[12:13], v20 offset:2464
    ds_read_b64_tr_b16 a[14:15], v20 offset:2912
    ds_read_b64_tr_b16 a[16:17], v20 offset:3136
    ds_read_b64_tr_b16 a[18:19], v20 offset:3584
    ds_read_b64_tr_b16 a[20:21], v20 offset:4032
    ds_read_b64_tr_b16 a[22:23], v20 offset:4480
    ds_read_b64_tr_b16 a[24:25], v20 offset:4704
    ds_read_b64_tr_b16 a[26:27], v20 offset:5152
    ds_read_b64_tr_b16 a[28:29], v20 offset:5600
    ds_read_b64_tr_b16 a[30:31], v20 offset:6048
    ds_read_b64_tr_b16 a[32:33], v21 offset:0
    ds_read_b64_tr_b16 a[34:35], v21 offset:448
    ds_read_b64_tr_b16 a[36:37], v21 offset:896
    ds_read_b64_tr_b16 a[38:39], v21 offset:1344
    ds_read_b64_tr_b16 a[40:41], v21 offset:1568
    ds_read_b64_tr_b16 a[42:43], v21 offset:2016
    ds_read_b64_tr_b16 a[44:45], v21 offset:2464
WPAD71:
    s_cbranch_execz WRET0
    ds_read_b64_tr_b16 a[46:47], v21 offset:2912
    ds_read_b64_tr_b16 a[48:49], v21 offset:3136
    ds_read_b64_tr_b16 a[50:51], v21 offset:3584
    ds_read_b64_tr_b16 a[52:53], v21 offset:4032
    ds_read_b64_tr_b16 a[54:55], v21 offset:4480
    ds_read_b64_tr_b16 a[56:57], v21 offset:4704
    ds_read_b64_tr_b16 a[58:59], v21 offset:5152
    ds_read_b64_tr_b16 a[60:61], v21 offset:5600
    ds_read_b64_tr_b16 a[62:63], v21 offset:6048
    ds_read_b64_tr_b16 a[64:65], v22 offset:0
    ds_read_b64_tr_b16 a[66:67], v22 offset:448
    ds_read_b64_tr_b16 a[68:69], v22 offset:896
    ds_read_b64_tr_b16 a[70:71], v22 offset:1344
    ds_read_b64_tr_b16 a[72:73], v22 offset:1568
    ds_read_b64_tr_b16 a[74:75], v22 offset:2016
    ds_read_b64_tr_b16 a[76:77], v22 offset:2464
    ds_read_b64_tr_b16 a[78:79], v22 offset:2912
    ds_read_b64_tr_b16 a[80:81], v22 offset:3136
    ds_read_b64_tr_b16 a[82:83], v22 offset:3584
    ds_read_b64_tr_b16 a[84:85], v22 offset:4032
    ds_read_b64_tr_b16 a[86:87], v22 offset:4480
    ds_read_b64_tr_b16 a[88:89], v22 offset:4704
    ds_read_b64_tr_b16 a[90:91], v22 offset:5152
    ds_read_b64_tr_b16 a[92:93], v22 offset:5600
    ds_read_b64_tr_b16 a[94:95], v22 offset:6048
    ds_read_b64_tr_b16 a[96:97], v23 offset:0
    ds_read_b64_tr_b16 a[98:99], v23 offset:448
    ds_read_b64_tr_b16 a[100:101], v23 offset:896
    ds_read_b64_tr_b16 a[102:103], v23 offset:1344
    ds_read_b64_tr_b16 a[104:105], v23 offset:1568
    ds_read_b64_tr_b16 a[106:107], v23 offset:2016
    ds_read_b64_tr_b16 a[108:109], v23 offset:2464
    ds_read_b64_tr_b16 a[110:111], v23 offset:2912
    ds_read_b64_tr_b16 a[112:113], v23 offset:3136
    ds_read_b64_tr_b16 a[114:115], v23 offset:3584
    ds_read_b64_tr_b16 a[116:117], v23 offset:4032
    ds_read_b64_tr_b16 a[118:119], v23 offset:4480
    ds_read_b64_tr_b16 a[120:121], v23 offset:4704
    ds_read_b64_tr_b16 a[122:123], v23 offset:5152
    ds_read_b64_tr_b16 a[124:125], v23 offset:5600
    ds_read_b64_tr_b16 a[126:127], v23 offset:6048
    v_lshlrev_b32 v144, 16, v192
    v_and_b32 v145, 0xffff0000, v192
    v_lshlrev_b32 v146, 16, v193
    v_and_b32 v147, 0xffff0000, v193
    v_lshlrev_b32 v148, 16, v194
    v_and_b32 v149, 0xffff0000, v194
    v_lshlrev_b32 v150, 16, v195
    v_and_b32 v151, 0xffff0000, v195
    v_lshlrev_b32 v152, 16, v196
    v_and_b32 v153, 0xffff0000, v196
    v_lshlrev_b32 v154, 16, v197
    v_and_b32 v155, 0xffff0000, v197
    v_lshlrev_b32 v156, 16, v198
    v_and_b32 v157, 0xffff0000, v198
    v_lshlrev_b32 v158, 16, v199
    v_and_b32 v159, 0xffff0000, v199
    buffer_load_dwordx4 v[208:211], v1, s[32:35], s82 offen offset:0 sc1
    buffer_load_dwordx4 v[212:215], v1, s[32:35], s82 offen offset:1024 sc1
    buffer_load_dwordx4 v[216:219], v1, s[32:35], s82 offen offset:2048 sc1
    buffer_load_dwordx4 v[220:223], v1, s[32:35], s82 offen offset:3072 sc1
    buffer_load_dwordx4 v[224:227], v1, s[32:35], s83 offen offset:0 sc1
    buffer_load_dwordx4 v[228:231], v1, s[32:35], s83 offen offset:1024 sc1
    buffer_load_dwordx4 v[232:235], v1, s[32:35], s83 offen offset:2048 sc1
    buffer_load_dwordx4 v[236:239], v1, s[32:35], s83 offen offset:3072 sc1
    s_waitcnt vmcnt(15)
    v_dot2_f32_bf16 v128, v160, s87, 0
    v_dot2_f32_bf16 v129, v160, s88, 0
WPAD72:
    s_cbranch_execz WRET0
    v_dot2_f32_bf16 v130, v161, s87, 0
    v_dot2_f32_bf16 v131, v161, s88, 0
    s_waitcnt vmcnt(13)
    v_dot2_f32_bf16 v128, v168, s87, v128
    v_dot2_f32_bf16 v129, v168, s88, v129
    v_dot2_f32_bf16 v130, v169, s87, v130
    v_dot2_f32_bf16 v131, v169, s88, v131
    s_waitcnt vmcnt(11)
    v_dot2_f32_bf16 v128, v176, s87, v128
    v_dot2_f32_bf16 v129, v176, s88, v129
    v_dot2_f32_bf16 v130, v177, s87, v130
    v_dot2_f32_bf16 v131, v177, s88, v131
    s_waitcnt vmcnt(9)
    v_dot2_f32_bf16 v128, v184, s87, v128
    v_dot2_f32_bf16 v129, v184, s88, v129
    v_dot2_f32_bf16 v130, v185, s87, v130
    v_dot2_f32_bf16 v131, v185, s88, v131
    v_exp_f32 v28, -v128
    v_exp_f32 v29, -v129
    v_exp_f32 v30, -v130
    v_exp_f32 v31, -v131
    v_add_f32 v28, 1.0, v28
    v_add_f32 v29, 1.0, v29
    v_add_f32 v30, 1.0, v30
    v_add_f32 v31, 1.0, v31
    v_rcp_f32 v28, v28
    v_rcp_f32 v29, v29
    v_rcp_f32 v30, v30
    v_rcp_f32 v31, v31
    v_mul_f32 v128, v128, v28
    v_mul_f32 v129, v129, v29
    v_mul_f32 v130, v130, v30
    v_mul_f32 v131, v131, v31
    v_dot2_f32_bf16 v132, v162, s87, 0
    v_dot2_f32_bf16 v133, v162, s88, 0
    v_dot2_f32_bf16 v134, v163, s87, 0
    v_dot2_f32_bf16 v135, v163, s88, 0
    v_dot2_f32_bf16 v132, v170, s87, v132
    v_dot2_f32_bf16 v133, v170, s88, v133
    v_dot2_f32_bf16 v134, v171, s87, v134
    v_dot2_f32_bf16 v135, v171, s88, v135
    v_dot2_f32_bf16 v132, v178, s87, v132
    v_dot2_f32_bf16 v133, v178, s88, v133
    v_dot2_f32_bf16 v134, v179, s87, v134
    v_dot2_f32_bf16 v135, v179, s88, v135
    v_dot2_f32_bf16 v132, v186, s87, v132
    v_dot2_f32_bf16 v133, v186, s88, v133
    v_dot2_f32_bf16 v134, v187, s87, v134
    v_dot2_f32_bf16 v135, v187, s88, v135
    v_exp_f32 v28, -v132
    v_exp_f32 v29, -v133
    v_exp_f32 v30, -v134
    v_exp_f32 v31, -v135
    v_add_f32 v28, 1.0, v28
    v_add_f32 v29, 1.0, v29
    v_add_f32 v30, 1.0, v30
    v_add_f32 v31, 1.0, v31
    v_rcp_f32 v28, v28
    v_rcp_f32 v29, v29
    v_rcp_f32 v30, v30
    v_rcp_f32 v31, v31
    v_mul_f32 v132, v132, v28
    v_mul_f32 v133, v133, v29
    v_mul_f32 v134, v134, v30
    v_mul_f32 v135, v135, v31
    v_dot2_f32_bf16 v136, v164, s87, 0
    v_dot2_f32_bf16 v137, v164, s88, 0
    v_dot2_f32_bf16 v138, v165, s87, 0
    v_dot2_f32_bf16 v139, v165, s88, 0
    v_dot2_f32_bf16 v136, v172, s87, v136
    v_dot2_f32_bf16 v137, v172, s88, v137
    v_dot2_f32_bf16 v138, v173, s87, v138
    v_dot2_f32_bf16 v139, v173, s88, v139
    v_dot2_f32_bf16 v136, v180, s87, v136
    v_dot2_f32_bf16 v137, v180, s88, v137
    v_dot2_f32_bf16 v138, v181, s87, v138
    v_dot2_f32_bf16 v139, v181, s88, v139
WPAD73:
    s_cbranch_execz WRET0
    s_waitcnt vmcnt(8)
    v_dot2_f32_bf16 v136, v188, s87, v136
    v_dot2_f32_bf16 v137, v188, s88, v137
    v_dot2_f32_bf16 v138, v189, s87, v138
    v_dot2_f32_bf16 v139, v189, s88, v139
    v_exp_f32 v28, -v136
    v_exp_f32 v29, -v137
    v_exp_f32 v30, -v138
    v_exp_f32 v31, -v139
    v_add_f32 v28, 1.0, v28
    v_add_f32 v29, 1.0, v29
    v_add_f32 v30, 1.0, v30
    v_add_f32 v31, 1.0, v31
    v_rcp_f32 v28, v28
    v_rcp_f32 v29, v29
    v_rcp_f32 v30, v30
    v_rcp_f32 v31, v31
    v_mul_f32 v136, v136, v28
    v_mul_f32 v137, v137, v29
    v_mul_f32 v138, v138, v30
    v_mul_f32 v139, v139, v31
    v_dot2_f32_bf16 v140, v166, s87, 0
    v_dot2_f32_bf16 v141, v166, s88, 0
    v_dot2_f32_bf16 v142, v167, s87, 0
    v_dot2_f32_bf16 v143, v167, s88, 0
    v_dot2_f32_bf16 v140, v174, s87, v140
    v_dot2_f32_bf16 v141, v174, s88, v141
    v_dot2_f32_bf16 v142, v175, s87, v142
    v_dot2_f32_bf16 v143, v175, s88, v143
    v_dot2_f32_bf16 v140, v182, s87, v140
    v_dot2_f32_bf16 v141, v182, s88, v141
    v_dot2_f32_bf16 v142, v183, s87, v142
    v_dot2_f32_bf16 v143, v183, s88, v143
    v_dot2_f32_bf16 v140, v190, s87, v140
    v_dot2_f32_bf16 v141, v190, s88, v141
    v_dot2_f32_bf16 v142, v191, s87, v142
    v_dot2_f32_bf16 v143, v191, s88, v143
    v_exp_f32 v28, -v140
    v_exp_f32 v29, -v141
    v_exp_f32 v30, -v142
    v_exp_f32 v31, -v143
    v_add_f32 v28, 1.0, v28
    v_add_f32 v29, 1.0, v29
    v_add_f32 v30, 1.0, v30
    v_add_f32 v31, 1.0, v31
    v_rcp_f32 v28, v28
    v_rcp_f32 v29, v29
    v_rcp_f32 v30, v30
    v_rcp_f32 v31, v31
    v_mul_f32 v140, v140, v28
    v_mul_f32 v141, v141, v29
    v_mul_f32 v142, v142, v30
    v_mul_f32 v143, v143, v31
    s_waitcnt vmcnt(7)
    v_max3_u32 v24, v208, v209, v210
    s_waitcnt vmcnt(6)
    v_max3_u32 v25, v211, v212, v213
    v_max3_u32 v24, v24, v214, v215
    s_waitcnt vmcnt(5)
    v_max3_u32 v25, v25, v216, v217
    v_max3_u32 v24, v24, v218, v219
    s_waitcnt vmcnt(4)
    v_max3_u32 v25, v25, v220, v221
    v_max3_u32 v24, v24, v222, v223
    s_waitcnt vmcnt(3)
    v_max3_u32 v25, v25, v224, v225
    v_max3_u32 v24, v24, v226, v227
    s_waitcnt vmcnt(2)
    v_max3_u32 v25, v25, v228, v229
    v_max3_u32 v24, v24, v230, v231
    s_waitcnt vmcnt(1)
    v_max3_u32 v25, v25, v232, v233
    v_max3_u32 v24, v24, v234, v235
    s_waitcnt vmcnt(0)
    v_max3_u32 v25, v25, v236, v237
    v_max3_u32 v24, v24, v238, v239
    v_max_u32 v24, v24, v25
    v_cmp_eq_u32 vcc, -1, v24
    s_cbranch_vccnz OSPIN
ORET:
    s_waitcnt lgkmcnt(0)
    ds_write_b128 v10, v[208:211] offset:25600
    ds_write_b128 v10, v[212:215] offset:26624
WPAD74:
    s_cbranch_execz WRET0
    ds_write_b128 v10, v[216:219] offset:27648
    ds_write_b128 v10, v[220:223] offset:28672
    ds_write_b128 v10, v[224:227] offset:29696
    ds_write_b128 v10, v[228:231] offset:30720
    ds_write_b128 v10, v[232:235] offset:31744
    ds_write_b128 v10, v[236:239] offset:32768
    v_mfma_f32_32x32x16_bf16 v[112:127], a[0:3], v[208:211], 0
    s_waitcnt lgkmcnt(0)
    s_barrier
    ds_read_b128 v[16:19], v2 offset:25600
    ds_read_b128 v[20:23], v2 offset:26624
    ds_read_b128 v[24:27], v2 offset:27648
    v_mfma_f32_32x32x16_bf16 v[112:127], a[4:7], v[212:215], v[112:127]
    ds_read_b128 v[28:31], v2 offset:28672
    ds_read_b128 v[32:35], v2 offset:29696
    ds_read_b128 v[36:39], v2 offset:30720
    v_mfma_f32_32x32x16_bf16 v[112:127], a[8:11], v[216:219], v[112:127]
    ds_read_b128 v[40:43], v2 offset:31744
    ds_read_b128 v[44:47], v2 offset:32768
    ds_read_b128 v[48:51], v3 offset:25600
    v_mfma_f32_32x32x16_bf16 v[112:127], a[12:15], v[220:223], v[112:127]
    ds_read_b128 v[52:55], v3 offset:26624
    ds_read_b128 v[56:59], v3 offset:27648
    ds_read_b128 v[60:63], v3 offset:28672
    v_mfma_f32_32x32x16_bf16 v[112:127], a[16:19], v[224:227], v[112:127]
    ds_read_b128 v[64:67], v3 offset:29696
    ds_read_b128 v[68:71], v3 offset:30720
    ds_read_b128 v[72:75], v3 offset:31744
    v_mfma_f32_32x32x16_bf16 v[112:127], a[20:23], v[228:231], v[112:127]
    ds_read_b128 v[76:79], v3 offset:32768
    ds_read_b128 v[80:83], v4 offset:25600
    ds_read_b128 v[84:87], v4 offset:26624
    v_mfma_f32_32x32x16_bf16 v[112:127], a[24:27], v[232:235], v[112:127]
    ds_read_b128 v[88:91], v4 offset:27648
    ds_read_b128 v[92:95], v4 offset:28672
    ds_read_b128 v[96:99], v4 offset:29696
    v_mfma_f32_32x32x16_bf16 v[112:127], a[28:31], v[236:239], v[112:127]
    s_waitcnt lgkmcnt(15)
    ds_read_b128 v[100:103], v4 offset:30720
    ds_read_b128 v[104:107], v4 offset:31744
    ds_read_b128 v[108:111], v4 offset:32768
    v_mfma_f32_32x32x16_bf16 v[112:127], a[32:35], v[16:19], v[112:127]
    v_mfma_f32_32x32x16_bf16 v[112:127], a[36:39], v[20:23], v[112:127]
    v_mfma_f32_32x32x16_bf16 v[112:127], a[40:43], v[24:27], v[112:127]
    v_mfma_f32_32x32x16_bf16 v[112:127], a[44:47], v[28:31], v[112:127]
    buffer_store_dword v12, v206, s[32:35], 0 offen sc1
    v_mfma_f32_32x32x16_bf16 v[112:127], a[48:51], v[32:35], v[112:127]
    v_mfma_f32_32x32x16_bf16 v[112:127], a[52:55], v[36:39], v[112:127]
    s_waitcnt lgkmcnt(15)
    v_mfma_f32_32x32x16_bf16 v[112:127], a[56:59], v[40:43], v[112:127]
    v_mfma_f32_32x32x16_bf16 v[112:127], a[60:63], v[44:47], v[112:127]
    v_mfma_f32_32x32x16_bf16 v[112:127], a[64:67], v[48:51], v[112:127]
    s_waitcnt lgkmcnt(14)
    v_mfma_f32_32x32x16_bf16 v[112:127], a[68:71], v[52:55], v[112:127]
    s_waitcnt lgkmcnt(13)
    v_mfma_f32_32x32x16_bf16 v[112:127], a[72:75], v[56:59], v[112:127]
    s_waitcnt lgkmcnt(12)
    v_mfma_f32_32x32x16_bf16 v[112:127], a[76:79], v[60:63], v[112:127]
    s_waitcnt lgkmcnt(11)
    v_mfma_f32_32x32x16_bf16 v[112:127], a[80:83], v[64:67], v[112:127]
    s_waitcnt lgkmcnt(10)
    v_mfma_f32_32x32x16_bf16 v[112:127], a[84:87], v[68:71], v[112:127]
    s_waitcnt lgkmcnt(9)
    v_mfma_f32_32x32x16_bf16 v[112:127], a[88:91], v[72:75], v[112:127]
    s_waitcnt lgkmcnt(8)
    v_mfma_f32_32x32x16_bf16 v[112:127], a[92:95], v[76:79], v[112:127]
    s_waitcnt lgkmcnt(7)
    v_mfma_f32_32x32x16_bf16 v[112:127], a[96:99], v[80:83], v[112:127]
    s_waitcnt lgkmcnt(6)
    v_mfma_f32_32x32x16_bf16 v[112:127], a[100:103], v[84:87], v[112:127]
WPAD75:
    s_cbranch_execz WRET0
    s_waitcnt lgkmcnt(5)
    v_mfma_f32_32x32x16_bf16 v[112:127], a[104:107], v[88:91], v[112:127]
    s_waitcnt lgkmcnt(4)
    v_mfma_f32_32x32x16_bf16 v[112:127], a[108:111], v[92:95], v[112:127]
    s_waitcnt lgkmcnt(3)
    v_mfma_f32_32x32x16_bf16 v[112:127], a[112:115], v[96:99], v[112:127]
    s_waitcnt lgkmcnt(2)
    v_mfma_f32_32x32x16_bf16 v[112:127], a[116:119], v[100:103], v[112:127]
    s_waitcnt lgkmcnt(1)
    v_mfma_f32_32x32x16_bf16 v[112:127], a[120:123], v[104:107], v[112:127]
    s_waitcnt lgkmcnt(0)
    v_mfma_f32_32x32x16_bf16 v[112:127], a[124:127], v[108:111], v[112:127]
    s_nop 11
    v_fma_f32 v144, v112, v128, v144
    v_fma_f32 v145, v113, v129, v145
    v_fma_f32 v146, v114, v130, v146
    v_fma_f32 v147, v115, v131, v147
    v_cvt_pk_bf16_f32 v192, v144, v145
    v_cvt_pk_bf16_f32 v193, v146, v147
    buffer_store_dwordx2 v[192:193], v200, s[28:31], 0 offen offset:0
    v_fma_f32 v148, v116, v132, v148
    v_fma_f32 v149, v117, v133, v149
    v_fma_f32 v150, v118, v134, v150
    v_fma_f32 v151, v119, v135, v151
    v_cvt_pk_bf16_f32 v194, v148, v149
    v_cvt_pk_bf16_f32 v195, v150, v151
    buffer_store_dwordx2 v[194:195], v200, s[28:31], 0 offen offset:16
    v_fma_f32 v152, v120, v136, v152
    v_fma_f32 v153, v121, v137, v153
    v_fma_f32 v154, v122, v138, v154
    v_fma_f32 v155, v123, v139, v155
    v_cvt_pk_bf16_f32 v196, v152, v153
    v_cvt_pk_bf16_f32 v197, v154, v155
    buffer_store_dwordx2 v[196:197], v200, s[28:31], 0 offen offset:32
    v_fma_f32 v156, v124, v140, v156
    v_fma_f32 v157, v125, v141, v157
    v_fma_f32 v158, v126, v142, v158
    v_fma_f32 v159, v127, v143, v159
    v_cvt_pk_bf16_f32 v198, v156, v157
    v_cvt_pk_bf16_f32 v199, v158, v159
    buffer_store_dwordx2 v[198:199], v201, s[28:31], 0 offen offset:48
    s_waitcnt vmcnt(0)
END:
    s_endpgm
SPIN_KV:
    s_mov_b32 s47, 0
SPINL_KV:
    buffer_load_dword v252, v14, s[32:35], s68 offen sc1
    s_waitcnt vmcnt(0)
    v_cmp_ne_u32 vcc, s46, v252
    s_cbranch_vccz RET_KV
    s_add_u32 s47, s47, 1
    s_cmp_lt_u32 s47, 200000
    s_cbranch_scc1 SPINL_KV
    s_branch RET_KV
SPIN_H:
    s_mov_b32 s47, 0
SPINL_H:
    buffer_load_dword v245, v9, s[32:35], s73 offen sc1
    s_waitcnt vmcnt(0)
    v_cmp_ne_u32 vcc, s46, v245
    s_cbranch_vccz RET_H
    s_add_u32 s47, s47, 1
    s_cmp_lt_u32 s47, 200000
    s_cbranch_scc1 SPINL_H
    s_branch RET_H
FB:
    v_accvgpr_read_b32 v16, a120
    v_accvgpr_read_b32 v17, a121
    v_accvgpr_read_b32 v18, a122
    v_accvgpr_read_b32 v19, a123
    v_accvgpr_read_b32 v20, a124
    v_accvgpr_read_b32 v21, a125
    v_accvgpr_read_b32 v22, a126
    v_accvgpr_read_b32 v23, a127
    v_cndmask_b32 v22, v22, 0, s[94:95]
    s_lshl_b32 s85, s41, 18
    s_add_u32 s85, s85, 65536
    s_mov_b32 s86, s85
    s_mov_b32 s47, 64
    v_mov_b32 v24, 0xff800000
FB1:
    buffer_load_dwordx4 v[80:83], v1, s[32:35], s86 offen sc1
    s_nop 0
WPAD76:
    s_cbranch_execz WRET0
    buffer_load_dwordx4 v[84:87], v1, s[32:35], s86 offen offset:1024 sc1
    s_waitcnt vmcnt(0)
    v_mfma_f32_32x32x16_bf16 v[32:47], v[80:83], v[16:19], 0
    v_mfma_f32_32x32x16_bf16 v[32:47], v[84:87], v[20:23], v[32:47]
    s_nop 11
    v_max3_f32 v24, v24, v32, v33
    v_max3_f32 v24, v24, v34, v35
    v_max3_f32 v24, v24, v36, v37
    v_max3_f32 v24, v24, v38, v39
    v_max3_f32 v24, v24, v40, v41
    v_max3_f32 v24, v24, v42, v43
    v_max3_f32 v24, v24, v44, v45
    v_max3_f32 v24, v24, v46, v47
    s_add_u32 s86, s86, 4096
    s_sub_u32 s47, s47, 1
    s_cmp_lg_u32 s47, 0
    s_cbranch_scc1 FB1
    v_mov_b32 v25, v24
    s_mov_b32 s47, 64
    s_nop 0
    v_permlane32_swap_b32 v24, v25
    v_max_f32 v24, v24, v25
    v_mov_b32 v64, 0
    v_mov_b32 v65, 0
    v_mov_b32 v66, 0
    v_mov_b32 v67, 0
    v_mov_b32 v68, 0
    v_mov_b32 v69, 0
    v_mov_b32 v70, 0
    v_mov_b32 v71, 0
    v_mov_b32 v72, 0
    v_mov_b32 v73, 0
    v_mov_b32 v74, 0
    v_mov_b32 v75, 0
    v_mov_b32 v76, 0
    v_mov_b32 v77, 0
    v_mov_b32 v78, 0
    v_mov_b32 v79, 0
FB2:
    buffer_load_dwordx4 v[80:83], v1, s[32:35], s85 offen offset:0 sc1
    buffer_load_dwordx4 v[84:87], v1, s[32:35], s85 offen offset:1024 sc1
    buffer_load_dwordx4 v[88:91], v1, s[32:35], s85 offen offset:2048 sc1
    buffer_load_dwordx4 v[92:95], v1, s[32:35], s85 offen offset:3072 sc1
    s_waitcnt vmcnt(0)
    v_mfma_f32_32x32x16_bf16 v[32:47], v[80:83], v[16:19], 0
    v_mfma_f32_32x32x16_bf16 v[32:47], v[84:87], v[20:23], v[32:47]
    s_nop 11
    v_sub_f32 v32, v32, v24
    v_sub_f32 v33, v33, v24
    v_sub_f32 v34, v34, v24
    v_sub_f32 v35, v35, v24
    v_sub_f32 v36, v36, v24
    v_sub_f32 v37, v37, v24
    v_sub_f32 v38, v38, v24
    v_sub_f32 v39, v39, v24
    v_sub_f32 v40, v40, v24
    v_sub_f32 v41, v41, v24
    v_sub_f32 v42, v42, v24
    v_sub_f32 v43, v43, v24
    v_sub_f32 v44, v44, v24
    v_sub_f32 v45, v45, v24
    v_sub_f32 v46, v46, v24
    v_sub_f32 v47, v47, v24
    v_exp_f32 v32, v32
    v_exp_f32 v33, v33
    v_exp_f32 v34, v34
    v_exp_f32 v35, v35
    v_exp_f32 v36, v36
    v_exp_f32 v37, v37
    v_exp_f32 v38, v38
    v_exp_f32 v39, v39
    v_exp_f32 v40, v40
    v_exp_f32 v41, v41
    v_exp_f32 v42, v42
    v_exp_f32 v43, v43
    v_exp_f32 v44, v44
    v_exp_f32 v45, v45
    v_exp_f32 v46, v46
    v_exp_f32 v47, v47
    v_cvt_pk_bf16_f32 v48, v32, v33
    v_cvt_pk_bf16_f32 v49, v34, v35
    v_cvt_pk_bf16_f32 v50, v36, v37
    v_cvt_pk_bf16_f32 v51, v38, v39
    v_cvt_pk_bf16_f32 v52, v40, v41
    v_cvt_pk_bf16_f32 v53, v42, v43
    v_cvt_pk_bf16_f32 v54, v44, v45
    v_cvt_pk_bf16_f32 v55, v46, v47
    v_mfma_f32_32x32x16_bf16 v[64:79], v[88:91], v[48:51], v[64:79]
    s_nop 0
    v_mfma_f32_32x32x16_bf16 v[64:79], v[92:95], v[52:55], v[64:79]
    s_add_u32 s85, s85, 4096
    s_sub_u32 s47, s47, 1
    s_cmp_lg_u32 s47, 0
    s_cbranch_scc1 FB2
    s_nop 7
    v_mov_b32 v16, v76
    v_mov_b32 v17, v76
    s_nop 1
    v_permlane32_swap_b32 v16, v17
WPAD77:
    s_cbranch_execz WRET0
    s_nop 1
    s_branch FB_RET
SPIN_P:
    s_mov_b32 s47, 0
SPINL_P:
    buffer_load_dword v246, v9, s[32:35], s77 offen sc1
    s_waitcnt vmcnt(0)
    v_cmp_ne_u32 vcc, s46, v246
    s_cbranch_vccz RET_P
    s_add_u32 s47, s47, 1
    s_cmp_lt_u32 s47, 200000
    s_cbranch_scc1 SPINL_P
    s_branch RET_P
OSPIN:
    s_mov_b32 s47, 0
OSPINL:
    s_add_u32 s47, s47, 1
    s_cmp_ge_u32 s47, 200000
    s_cbranch_scc1 ORET
    buffer_load_dword v24, v207, s[32:35], s82 offen sc1
    buffer_load_dword v25, v207, s[32:35], s83 offen sc1
    s_waitcnt vmcnt(0)
    v_max_u32 v24, v24, v25
    v_cmp_eq_u32 vcc, -1, v24
    s_cbranch_vccnz OSPINL
    buffer_load_dwordx4 v[208:211], v1, s[32:35], s82 offen offset:0 sc1
    buffer_load_dwordx4 v[212:215], v1, s[32:35], s82 offen offset:1024 sc1
    buffer_load_dwordx4 v[216:219], v1, s[32:35], s82 offen offset:2048 sc1
    buffer_load_dwordx4 v[220:223], v1, s[32:35], s82 offen offset:3072 sc1
    buffer_load_dwordx4 v[224:227], v1, s[32:35], s83 offen offset:0 sc1
    buffer_load_dwordx4 v[228:231], v1, s[32:35], s83 offen offset:1024 sc1
    buffer_load_dwordx4 v[232:235], v1, s[32:35], s83 offen offset:2048 sc1
    buffer_load_dwordx4 v[236:239], v1, s[32:35], s83 offen offset:3072 sc1
    s_waitcnt vmcnt(0)
    v_max3_u32 v24, v208, v209, v210
    v_max3_u32 v25, v211, v212, v213
    v_max3_u32 v24, v24, v214, v215
    v_max3_u32 v25, v25, v216, v217
    v_max3_u32 v24, v24, v218, v219
    v_max3_u32 v25, v25, v220, v221
    v_max3_u32 v24, v24, v222, v223
    v_max3_u32 v25, v25, v224, v225
    v_max3_u32 v24, v24, v226, v227
    v_max3_u32 v25, v25, v228, v229
    v_max3_u32 v24, v24, v230, v231
    v_max3_u32 v25, v25, v232, v233
    v_max3_u32 v24, v24, v234, v235
    v_max3_u32 v25, v25, v236, v237
    v_max3_u32 v24, v24, v238, v239
    v_max_u32 v24, v24, v25
    v_cmp_eq_u32 vcc, -1, v24
    s_cbranch_vccnz OSPINL
    s_branch ORET
.section .rodata,"a"
.p2align 6
.amdhsa_kernel recurrent_scan__mha_block__swiglu_ffn__prompt_kernel
  .amdhsa_next_free_vgpr 512
  .amdhsa_next_free_sgpr 102
  .amdhsa_accum_offset 256
  .amdhsa_group_segment_fixed_size 0
  .amdhsa_kernarg_size 80
  .amdhsa_user_sgpr_count 2
  .amdhsa_user_sgpr_kernarg_segment_ptr 1
  .amdhsa_system_sgpr_workgroup_id_x 1
.end_amdhsa_kernel
```
